```python
import torch

def _softmax(x, axis=-1):
    return torch.softmax(x, dim=axis)
def _gelu(x):
    return torch.nn.functional.gelu(x, approximate="tanh")
def _silu(x):
    return torch.nn.functional.silu(x)
def _sigmoid(x):
    return torch.sigmoid(x)
def _layernorm(x, axis=-1, eps=1e-5):
    m = x.mean(dim=axis, keepdim=True)
    v = x.var(dim=axis, keepdim=True, unbiased=False)
    return (x - m) / torch.sqrt(v + eps)
def _scatter_add(tgt, idx, src, axis=0):
    return tgt.clone().index_add_(axis, idx, src)
def _segment_sum(src, seg, n):
    out = torch.zeros((n,) + src.shape[1:], dtype=src.dtype)
    return out.index_add_(0, seg, src)
def _pad(x, pw):
    flat = tuple(v for pair in reversed(pw) for v in pair)
    return torch.nn.functional.pad(x, flat)

kernel_name = 'concat_heads__gqa_block_cached__mha_block_cached__decode'

def setup_inputs():

    _w = (lambda a: (lambda t: t.to(torch.bfloat16) if t.is_floating_point() else t)(torch.as_tensor(a)))
    def _A_setup():
        B, Sq, D = 4, 1, 640
        Hq, Hkv, Sk, Dh = 32, 32, 4096, 192
        assert Hq % Hkv == 0, (Hq, Hkv)
        return {
            "x": _w((lambda *s: torch.randn(*s, dtype=torch.bfloat16) * 0.8)(B, Sq, D)),
            "k_cache": _w((lambda *s: torch.randn(*s, dtype=torch.bfloat16) * 0.8)(B, Hkv, Sk, Dh)),
            "v_cache": _w((lambda *s: torch.randn(*s, dtype=torch.bfloat16) * 0.05)(B, Hkv, Sk, Dh)),
            "wq": _w((lambda *s: torch.randn(*s, dtype=torch.bfloat16) * 0.8)(D, Hq * Dh) * (D ** -0.5)),
            "wo": _w((lambda *s: torch.randn(*s, dtype=torch.bfloat16) * 0.05)(Hq * Dh, D) * ((Hq * Dh) ** -0.5)),
        }
    _A_in = _A_setup()

    def _B_setup():
        B, Sq, D = 4, 1, 640
        H, Sk, Dh = 32, 4096, 192
        return {
            "x": _w((lambda *s: torch.randn(*s, dtype=torch.bfloat16) * 0.8)(B, Sq, D)),
            "k_cache": _w((lambda *s: torch.randn(*s, dtype=torch.bfloat16) * 0.8)(B, H, Sk, Dh)),
            "v_cache": _w((lambda *s: torch.randn(*s, dtype=torch.bfloat16) * 0.05)(B, H, Sk, Dh)),
            "wq": _w((lambda *s: torch.randn(*s, dtype=torch.bfloat16) * 0.8)(D, H * Dh) * (D ** -0.5)),
            "wo": _w((lambda *s: torch.randn(*s, dtype=torch.bfloat16) * 0.05)(H * Dh, D) * ((H * Dh) ** -0.5)),
        }
    _B_in = _B_setup()

    return {
        "A_x": _A_in["x"],
        "A_k_cache": _A_in["k_cache"],
        "A_v_cache": _A_in["v_cache"],
        "A_wq": _A_in["wq"],
        "A_wo": _A_in["wo"],
        "B_x": _B_in["x"],
        "B_k_cache": _B_in["k_cache"],
        "B_v_cache": _B_in["v_cache"],
        "B_wq": _B_in["wq"],
        "B_wo": _B_in["wo"],
    }

def reference(A_x, A_k_cache, A_v_cache, A_wq, A_wo, B_x, B_k_cache, B_v_cache, B_wq, B_wo):
    def _A_ref(x, k_cache, v_cache, wq, wo):
        B, Sq, D = x.shape
        Hq, Dh = 32, 192
        Hkv = k_cache.shape[1]
        rep = Hq // Hkv
        q = (lambda x, *d: x.permute(*d))((x @ wq).reshape(B, Sq, Hq, Dh), 0, 2, 1, 3)
        k = (lambda x, n, axis: torch.repeat_interleave(x, n, dim=axis))(k_cache, rep, axis=1)
        v = (lambda x, n, axis: torch.repeat_interleave(x, n, dim=axis))(v_cache, rep, axis=1)
        scores = torch.einsum("bhqd,bhkd->bhqk", q, k) * (Dh ** -0.5)
        p = _softmax(scores, axis=-1)
        o = torch.einsum("bhqk,bhkd->bhqd", p, v)
        return (lambda x, *d: x.permute(*d))(o, 0, 2, 1, 3).reshape(B, Sq, Hq * Dh) @ wo

    def _B_ref(x, k_cache, v_cache, wq, wo):
        B, Sq, D = x.shape
        H, Dh = 32, 192
        q = (lambda x, *d: x.permute(*d))((x @ wq).reshape(B, Sq, H, Dh), 0, 2, 1, 3)
        scores = torch.einsum("bhqd,bhkd->bhqk", q, k_cache) * (Dh ** -0.5)
        p = _softmax(scores, axis=-1)
        o = torch.einsum("bhqk,bhkd->bhqd", p, v_cache)
        return (lambda x, *d: x.permute(*d))(o, 0, 2, 1, 3).reshape(B, Sq, H * Dh) @ wo

    a = _A_ref(A_x, A_k_cache, A_v_cache, A_wq, A_wo)
    b = _B_ref(B_x, B_k_cache, B_v_cache, B_wq, B_wo)
    return torch.concatenate([a, b], axis=-1)
```

```asm
; @launch grid=(256,1,1) block=(256,1,1) lds=57984
.amdgcn_target "amdgcn-amd-amdhsa--gfx950"
.text
.globl concat_heads__gqa_block_cached__mha_block_cached__decode_kernel
.p2align 8
.type concat_heads__gqa_block_cached__mha_block_cached__decode_kernel,@function
concat_heads__gqa_block_cached__mha_block_cached__decode_kernel:
    s_cmp_ge_u32 s2, 256
    s_cbranch_scc1 L_end
    s_lshr_b32 s44, s2, 7
    s_mul_i32 s6, s44, 40
    s_add_u32 s6, s0, s6
    s_addc_u32 s7, s1, 0
    s_load_dwordx4 s[8:11], s[6:7], 8
    s_memrealtime s[82:83]
    s_bfe_u32 s12, s2, 0x20003
    s_lshl_b32 s12, s12, 5
    s_and_b32 s3, s2, 7
    s_or_b32 s12, s12, s3
    s_lshr_b32 s3, s2, 2
    s_and_b32 s3, s3, 0x18
    s_or_b32 s12, s12, s3
    v_lshrrev_b32 v7, 6, v0
    v_bfe_u32 v5, v0, 2, 2
    v_mul_u32_u24 v5, 384, v5
    v_readfirstlane_b32 s13, v7
    v_bfe_u32 v14, v0, 5, 1
    v_mul_u32_u24 v14, 32640, v14
    v_bfe_u32 v15, v0, 4, 1
    v_lshl_add_u32 v5, v15, 6, v5
    v_and_b32 v15, 3, v0
    v_lshlrev_b32 v15, 4, v15
    v_add3_u32 v5, v5, v14, v15
    s_mul_i32 s3, s2, 37
    s_bfe_u32 s87, s3, 0x30004
    s_mul_i32 s87, s87, 196608
    s_and_b32 s3, s3, 15
    s_min_u32 s3, s3, 14
    s_lshl2_add_u32 s86, s3, s13
    s_mul_i32 s3, s86, 49
    s_lshr_b32 s3, s3, 10
    s_mul_i32 s3, s3, 33408
    s_mul_i32 s47, s86, 1536
    s_add_u32 s3, s3, s87
    s_add_u32 s47, s47, s3
    s_mov_b32 s18, 1572864
    s_mul_i32 s5, s12, s18
    s_mov_b32 s19, 0x20000
    s_waitcnt lgkmcnt(0)
    s_add_u32 s16, s8, s5
    s_addc_u32 s17, s9, 0
    buffer_load_dwordx4 a[0:3], v5, s[16:19], s47 offen offset:0 nt
    buffer_load_dwordx4 a[4:7], v5, s[16:19], s47 offen offset:128 nt
    buffer_load_dwordx4 a[8:11], v5, s[16:19], s47 offen offset:256 nt
    s_add_u32 s86, s86, 4
    s_cmp_ge_u32 s86, 63
    s_cselect_b32 s3, 63, 0
    s_cselect_b32 s4, 196608, 0
    s_sub_u32 s86, s86, s3
    s_add_u32 s87, s87, s4
    s_cmp_eq_u32 s87, s18
    s_cselect_b32 s87, 0, s87
    s_mul_i32 s3, s86, 49
    s_lshr_b32 s3, s3, 10
    s_mul_i32 s3, s3, 33408
    s_mul_i32 s47, s86, 1536
    s_add_u32 s3, s3, s87
    s_add_u32 s47, s47, s3
    s_load_dwordx2 s[14:15], s[6:7], 0
    s_load_dwordx4 s[52:55], s[6:7], 24
    s_load_dwordx4 s[36:39], s[0:1], 80
    s_load_dwordx2 s[92:93], s[0:1], 96
    buffer_load_dwordx4 a[12:15], v5, s[16:19], s47 offen offset:0 nt
    buffer_load_dwordx4 a[16:19], v5, s[16:19], s47 offen offset:128 nt
    buffer_load_dwordx4 a[20:23], v5, s[16:19], s47 offen offset:256 nt
    s_add_u32 s86, s86, 4
    s_cmp_ge_u32 s86, 63
    s_cselect_b32 s3, 63, 0
    s_cselect_b32 s4, 196608, 0
    s_sub_u32 s86, s86, s3
    s_add_u32 s87, s87, s4
    s_cmp_eq_u32 s87, s18
    s_cselect_b32 s87, 0, s87
    s_mul_i32 s3, s86, 49
    s_lshr_b32 s3, s3, 10
    s_mul_i32 s3, s3, 33408
    s_mul_i32 s47, s86, 1536
    s_add_u32 s3, s3, s87
    s_add_u32 s47, s47, s3
    s_add_u32 s20, s10, s5
    s_addc_u32 s21, s11, 0
    s_mov_b32 s22, 1572864
    s_mov_b32 s23, 0x20000
    s_lshr_b32 s42, s12, 5
    s_and_b32 s43, s12, 31
    s_add_u32 s80, s82, 1180
    s_movk_i32 s82, 358
    v_and_b32 v1, 63, v0
    v_lshrrev_b32 v8, 3, v1
    v_and_b32 v9, 7, v1
    v_lshlrev_b32 v10, 4, v9
    v_lshrrev_b32 v14, 3, v0
    v_mul_u32_u24 v15, 40, v14
    v_mul_u32_u24 v2, 245760, v14
    v_add_u32 v2, v2, v10
    s_movk_i32 s34, 1280
    s_mov_b32 s35, 0x20000
    s_mov_b32 s27, 0x20000
    s_mov_b32 s51, 0
    s_mul_i32 s3, s42, 1280
    s_mul_i32 s4, s43, 384
    s_sub_u32 s26, 7864320, s4
    s_waitcnt lgkmcnt(0)
    s_add_u32 s32, s14, s3
    s_addc_u32 s33, s15, 0
    s_add_u32 s24, s52, s4
    s_addc_u32 s25, s53, 0
    buffer_load_dwordx4 v[68:71], v15, s[32:35], 0 offen
    buffer_load_dwordx4 v[72:75], v15, s[32:35], 0 offen offset:16
    buffer_load_dwordx2 v[76:77], v15, s[32:35], 0 offen offset:32
    buffer_load_dwordx4 v[132:135], v2, s[24:27], s51 offen offset:0
    buffer_load_dwordx4 v[136:139], v2, s[24:27], s51 offen offset:128
    buffer_load_dwordx4 v[140:143], v2, s[24:27], s51 offen offset:256
    s_addk_i32 s51, 12288
    buffer_load_dwordx4 a[24:27], v5, s[16:19], s47 offen offset:0 nt
    buffer_load_dwordx4 a[28:31], v5, s[16:19], s47 offen offset:128 nt
    buffer_load_dwordx4 v[144:147], v2, s[24:27], s51 offen offset:0
    buffer_load_dwordx4 v[148:151], v2, s[24:27], s51 offen offset:128
    buffer_load_dwordx4 v[152:155], v2, s[24:27], s51 offen offset:256
    s_addk_i32 s51, 12288
    s_lshl_b32 s3, s44, 2
    s_add_u32 s3, s3, s42
    s_lshl_b32 s4, s3, 2
    s_add_u32 s4, s4, s13
    s_mul_i32 s4, s4, 20480
    s_add_u32 s4, s4, 131072
    s_add_u32 s40, s92, s4
    s_addc_u32 s41, s93, 0
    s_lshl_b32 s3, s3, 5
    s_add_u32 s38, s38, s3
    s_addc_u32 s39, s39, 0
    s_cmp_lg_u32 s13, 0
    s_cbranch_scc1 L_nonce
    s_or_b32 s96, s80, 1
    s_mov_b32 s97, 0
    s_mov_b32 s81, s96
    s_atomic_cmpswap s[96:97], s[38:39], 0x4 glc
L_nonce:
    buffer_load_dwordx4 a[32:35], v5, s[16:19], s47 offen offset:256 nt
    s_add_u32 s86, s86, 4
    s_cmp_ge_u32 s86, 63
    s_cselect_b32 s3, 63, 0
    s_cselect_b32 s4, 196608, 0
    s_sub_u32 s86, s86, s3
    s_add_u32 s87, s87, s4
    s_cmp_eq_u32 s87, s18
    s_cselect_b32 s87, 0, s87
    s_mul_i32 s3, s86, 49
    s_lshr_b32 s3, s3, 10
    s_mul_i32 s3, s3, 33408
    s_mul_i32 s47, s86, 1536
    s_add_u32 s3, s3, s87
    s_add_u32 s47, s47, s3
    buffer_load_dwordx4 a[36:39], v5, s[16:19], s47 offen offset:0 nt
    buffer_load_dwordx4 v[156:159], v2, s[24:27], s51 offen offset:0
    buffer_load_dwordx4 v[160:163], v2, s[24:27], s51 offen offset:128
    buffer_load_dwordx4 v[164:167], v2, s[24:27], s51 offen offset:256
    s_addk_i32 s51, 12288
    buffer_load_dwordx4 a[40:43], v5, s[16:19], s47 offen offset:128 nt
    buffer_load_dwordx4 a[44:47], v5, s[16:19], s47 offen offset:256 nt
    s_add_u32 s86, s86, 4
    s_cmp_ge_u32 s86, 63
    s_cselect_b32 s3, 63, 0
    s_cselect_b32 s4, 196608, 0
    s_sub_u32 s86, s86, s3
    s_add_u32 s87, s87, s4
    s_cmp_eq_u32 s87, s18
    s_cselect_b32 s87, 0, s87
    s_mul_i32 s3, s86, 49
    s_lshr_b32 s3, s3, 10
    s_mul_i32 s3, s3, 33408
    s_mul_i32 s47, s86, 1536
    s_add_u32 s3, s3, s87
    s_add_u32 s47, s47, s3
    buffer_load_dwordx4 v[168:171], v2, s[24:27], s51 offen offset:0
    buffer_load_dwordx4 v[172:175], v2, s[24:27], s51 offen offset:128
    buffer_load_dwordx4 v[176:179], v2, s[24:27], s51 offen offset:256
    s_addk_i32 s51, 12288
    buffer_load_dwordx4 a[48:51], v5, s[16:19], s47 offen offset:0 nt
    buffer_load_dwordx4 a[52:55], v5, s[16:19], s47 offen offset:128 nt
    buffer_load_dwordx4 v[180:183], v2, s[24:27], s51 offen offset:0
    buffer_load_dwordx4 v[184:187], v2, s[24:27], s51 offen offset:128
    buffer_load_dwordx4 v[188:191], v2, s[24:27], s51 offen offset:256
    s_addk_i32 s51, 12288
    buffer_load_dwordx4 a[56:59], v5, s[16:19], s47 offen offset:256 nt
    s_add_u32 s86, s86, 4
    s_cmp_ge_u32 s86, 63
    s_cselect_b32 s3, 63, 0
    s_cselect_b32 s4, 196608, 0
    s_sub_u32 s86, s86, s3
    s_add_u32 s87, s87, s4
    s_cmp_eq_u32 s87, s18
    s_cselect_b32 s87, 0, s87
    s_mul_i32 s3, s86, 49
    s_lshr_b32 s3, s3, 10
    s_mul_i32 s3, s3, 33408
    s_mul_i32 s47, s86, 1536
    s_add_u32 s3, s3, s87
    s_add_u32 s47, s47, s3
    buffer_load_dwordx4 a[60:63], v5, s[16:19], s47 offen offset:0 nt
    buffer_load_dwordx4 v[192:195], v2, s[24:27], s51 offen offset:0
    buffer_load_dwordx4 v[196:199], v2, s[24:27], s51 offen offset:128
    buffer_load_dwordx4 v[200:203], v2, s[24:27], s51 offen offset:256
    s_addk_i32 s51, 12288
    buffer_load_dwordx4 a[64:67], v5, s[16:19], s47 offen offset:128 nt
    buffer_load_dwordx4 a[68:71], v5, s[16:19], s47 offen offset:256 nt
    s_add_u32 s86, s86, 4
    s_cmp_ge_u32 s86, 63
    s_cselect_b32 s3, 63, 0
    s_cselect_b32 s4, 196608, 0
    s_sub_u32 s86, s86, s3
    s_add_u32 s87, s87, s4
    s_cmp_eq_u32 s87, s18
    s_cselect_b32 s87, 0, s87
    s_mul_i32 s3, s86, 49
    s_lshr_b32 s3, s3, 10
    s_mul_i32 s3, s3, 33408
    s_mul_i32 s47, s86, 1536
    s_add_u32 s3, s3, s87
    s_add_u32 s47, s47, s3
    buffer_load_dwordx4 v[204:207], v2, s[24:27], s51 offen offset:0
    buffer_load_dwordx4 v[208:211], v2, s[24:27], s51 offen offset:128
    buffer_load_dwordx4 v[212:215], v2, s[24:27], s51 offen offset:256
    s_addk_i32 s51, 12288
    buffer_load_dwordx4 a[72:75], v5, s[16:19], s47 offen offset:0 nt
    buffer_load_dwordx4 a[76:79], v5, s[16:19], s47 offen offset:128 nt
    buffer_load_dwordx4 v[216:219], v2, s[24:27], s51 offen offset:0
    buffer_load_dwordx4 v[220:223], v2, s[24:27], s51 offen offset:128
    buffer_load_dwordx4 v[224:227], v2, s[24:27], s51 offen offset:256
    s_addk_i32 s51, 12288
    buffer_load_dwordx4 a[80:83], v5, s[16:19], s47 offen offset:256 nt
    s_add_u32 s86, s86, 4
    s_cmp_ge_u32 s86, 63
    s_cselect_b32 s3, 63, 0
    s_cselect_b32 s4, 196608, 0
    s_sub_u32 s86, s86, s3
    s_add_u32 s87, s87, s4
    s_cmp_eq_u32 s87, s18
    s_cselect_b32 s87, 0, s87
    s_mul_i32 s3, s86, 49
    s_lshr_b32 s3, s3, 10
    s_mul_i32 s3, s3, 33408
    s_mul_i32 s47, s86, 1536
    s_add_u32 s3, s3, s87
    s_add_u32 s47, s47, s3
    buffer_load_dwordx4 a[84:87], v5, s[16:19], s47 offen offset:0 nt
    buffer_load_dwordx4 v[228:231], v2, s[24:27], s51 offen offset:0
    buffer_load_dwordx4 v[232:235], v2, s[24:27], s51 offen offset:128
    buffer_load_dwordx4 v[236:239], v2, s[24:27], s51 offen offset:256
    s_addk_i32 s51, 12288
    buffer_load_dwordx4 a[88:91], v5, s[16:19], s47 offen offset:128 nt
    buffer_load_dwordx4 a[92:95], v5, s[16:19], s47 offen offset:256 nt
    s_add_u32 s86, s86, 4
    s_cmp_ge_u32 s86, 63
    s_cselect_b32 s3, 63, 0
    s_cselect_b32 s4, 196608, 0
    s_sub_u32 s86, s86, s3
    s_add_u32 s87, s87, s4
    s_cmp_eq_u32 s87, s18
    s_cselect_b32 s87, 0, s87
    s_mul_i32 s3, s86, 49
    s_lshr_b32 s3, s3, 10
    s_mul_i32 s3, s3, 33408
    s_mul_i32 s47, s86, 1536
    s_add_u32 s3, s3, s87
    s_add_u32 s47, s47, s3
    buffer_load_dwordx4 v[240:243], v2, s[24:27], s51 offen offset:0
    buffer_load_dwordx4 v[244:247], v2, s[24:27], s51 offen offset:128
    buffer_load_dwordx4 v[248:251], v2, s[24:27], s51 offen offset:256
    s_addk_i32 s51, 12288
    buffer_load_dwordx4 a[96:99], v5, s[16:19], s47 offen offset:0 nt
    buffer_load_dwordx4 a[100:103], v5, s[16:19], s47 offen offset:128 nt
    buffer_load_dwordx4 a[104:107], v5, s[16:19], s47 offen offset:256 nt
    s_add_u32 s86, s86, 4
    s_cmp_ge_u32 s86, 63
    s_cselect_b32 s3, 63, 0
    s_cselect_b32 s4, 196608, 0
    s_sub_u32 s86, s86, s3
    s_add_u32 s87, s87, s4
    s_cmp_eq_u32 s87, s18
    s_cselect_b32 s87, 0, s87
    s_mul_i32 s3, s86, 49
    s_lshr_b32 s3, s3, 10
    s_mul_i32 s3, s3, 33408
    s_mul_i32 s47, s86, 1536
    s_add_u32 s3, s3, s87
    s_add_u32 s47, s47, s3
    v_lshrrev_b32 v6, 4, v1
    v_and_b32 v14, 1, v8
    v_lshl_add_u32 v6, v14, 2, v6
    v_mul_u32_u24 v80, 528, v6
    v_mul_u32_u24 v14, 31104, v14
    v_mul_u32_u24 v6, 384, v6
    v_add3_u32 v6, v6, v14, v10
    v_mul_u32_u24 v14, 4224, v7
    v_add_u32 v80, v80, v14
    v_add_u32 v80, 40960, v80
    v_mov_b32 v81, v80
    s_mul_i32 s3, s43, 245760
    s_add_u32 s28, s54, s3
    s_addc_u32 s29, s55, 0
    s_mov_b32 s30, 245760
    s_mov_b32 s31, 0x20000
    s_mov_b64 s[32:33], s[28:29]
    s_mov_b32 s35, 0x20000
    s_cmp_eq_u32 s42, 0
    s_cselect_b32 s34, 0, s30
    s_cselect_b32 s30, s30, 0
    v_lshrrev_b32 v14, 4, v0
    v_mul_u32_u24 v3, 15360, v14
    v_and_b32 v14, 15, v0
    v_lshl_add_u32 v3, v14, 4, v3
    v_and_b32 v14, 1, v1
    v_lshlrev_b32 v14, 4, v14
    v_mov_b32 v15, 0xffff
    v_lshlrev_b32 v15, v14, v15
    v_lshrrev_b32 v14, 1, v9
    v_cmp_eq_u32 vcc, 0, v14
    s_nop 1
    v_cndmask_b32 v16, 0, v15, vcc
    v_cmp_eq_u32 vcc, 1, v14
    s_nop 1
    v_cndmask_b32 v17, 0, v15, vcc
    v_cmp_eq_u32 vcc, 2, v14
    s_nop 1
    v_cndmask_b32 v18, 0, v15, vcc
    v_cmp_eq_u32 vcc, 3, v14
    s_nop 1
    v_cndmask_b32 v19, 0, v15, vcc
    v_lshrrev_b32 v14, 5, v0
    v_bfe_u32 v15, v1, 4, 1
    v_lshlrev_b32 v15, 4, v15
    v_lshl_add_u32 v15, v9, 5, v15
    v_mul_u32_u24 v78, 768, v14
    v_add_u32 v78, v78, v15
    v_mul_u32_u24 v79, 2560, v7
    v_bfe_u32 v15, v0, 4, 1
    v_lshl_add_u32 v79, v15, 4, v79
    v_and_b32 v15, 15, v0
    v_lshl_add_u32 v79, v15, 5, v79
    s_mov_b32 s56, 0x01000100
    s_mov_b32 s57, 0x03020302
    s_mov_b32 s50, 0x3dd53b95
    s_waitcnt vmcnt(51)
    v_perm_b32 v15, v68, v68, s56
    v_and_b32 v52, v15, v16
    v_and_b32 v53, v15, v17
    v_and_b32 v54, v15, v18
    v_and_b32 v55, v15, v19
    s_waitcnt vmcnt(48)
    s_nop 0
    v_mfma_f32_16x16x32_bf16 v[32:35], v[52:55], v[132:135], 0
    v_mfma_f32_16x16x32_bf16 v[36:39], v[52:55], v[136:139], 0
    v_mfma_f32_16x16x32_bf16 v[40:43], v[52:55], v[140:143], 0
    buffer_load_dwordx4 v[132:135], v2, s[24:27], s51 offen offset:0
    buffer_load_dwordx4 v[136:139], v2, s[24:27], s51 offen offset:128
    buffer_load_dwordx4 v[140:143], v2, s[24:27], s51 offen offset:256
    s_addk_i32 s51, 12288
    buffer_load_dwordx4 a[108:111], v5, s[16:19], s47 offen offset:0 nt
    buffer_load_dwordx4 a[112:115], v5, s[16:19], s47 offen offset:128 nt
    v_perm_b32 v15, v68, v68, s57
    v_and_b32 v56, v15, v16
    v_and_b32 v57, v15, v17
    v_and_b32 v58, v15, v18
    v_and_b32 v59, v15, v19
    s_waitcnt vmcnt(48)
    s_nop 0
    v_mfma_f32_16x16x32_bf16 v[32:35], v[56:59], v[144:147], v[32:35]
    v_mfma_f32_16x16x32_bf16 v[36:39], v[56:59], v[148:151], v[36:39]
    v_mfma_f32_16x16x32_bf16 v[40:43], v[56:59], v[152:155], v[40:43]
    buffer_load_dwordx4 v[144:147], v2, s[24:27], s51 offen offset:0
    buffer_load_dwordx4 v[148:151], v2, s[24:27], s51 offen offset:128
    buffer_load_dwordx4 v[152:155], v2, s[24:27], s51 offen offset:256
    s_addk_i32 s51, 12288
    buffer_load_dwordx4 a[116:119], v5, s[16:19], s47 offen offset:256 nt
    s_add_u32 s86, s86, 4
    s_cmp_ge_u32 s86, 63
    s_cselect_b32 s3, 63, 0
    s_cselect_b32 s4, 196608, 0
    s_sub_u32 s86, s86, s3
    s_add_u32 s87, s87, s4
    s_cmp_eq_u32 s87, s18
    s_cselect_b32 s87, 0, s87
    s_mul_i32 s3, s86, 49
    s_lshr_b32 s3, s3, 10
    s_mul_i32 s3, s3, 33408
    s_mul_i32 s47, s86, 1536
    s_add_u32 s3, s3, s87
    s_add_u32 s47, s47, s3
    buffer_load_dwordx4 a[120:123], v5, s[16:19], s47 offen offset:0 nt
    buffer_load_dwordx4 a[124:127], v5, s[16:19], s47 offen offset:128 nt
    v_perm_b32 v15, v69, v69, s56
    v_and_b32 v52, v15, v16
    v_and_b32 v53, v15, v17
    v_and_b32 v54, v15, v18
    v_and_b32 v55, v15, v19
    s_waitcnt vmcnt(49)
    s_nop 0
    v_mfma_f32_16x16x32_bf16 v[32:35], v[52:55], v[156:159], v[32:35]
    v_mfma_f32_16x16x32_bf16 v[36:39], v[52:55], v[160:163], v[36:39]
    v_mfma_f32_16x16x32_bf16 v[40:43], v[52:55], v[164:167], v[40:43]
    buffer_load_dwordx4 v[156:159], v2, s[24:27], s51 offen offset:0
    buffer_load_dwordx4 v[160:163], v2, s[24:27], s51 offen offset:128
    buffer_load_dwordx4 v[164:167], v2, s[24:27], s51 offen offset:256
    s_addk_i32 s51, 12288
    buffer_load_dwordx4 a[128:131], v5, s[16:19], s47 offen offset:256 nt
    s_add_u32 s86, s86, 4
    s_cmp_ge_u32 s86, 63
    s_cselect_b32 s3, 63, 0
    s_cselect_b32 s4, 196608, 0
    s_sub_u32 s86, s86, s3
    s_add_u32 s87, s87, s4
    s_cmp_eq_u32 s87, s18
    s_cselect_b32 s87, 0, s87
    s_mul_i32 s3, s86, 49
    s_lshr_b32 s3, s3, 10
    s_mul_i32 s3, s3, 33408
    s_mul_i32 s47, s86, 1536
    s_add_u32 s3, s3, s87
    s_add_u32 s47, s47, s3
    buffer_load_dwordx4 a[132:135], v5, s[16:19], s47 offen offset:0 nt
    v_perm_b32 v15, v69, v69, s57
    v_and_b32 v56, v15, v16
    v_and_b32 v57, v15, v17
    v_and_b32 v58, v15, v18
    v_and_b32 v59, v15, v19
    s_waitcnt vmcnt(49)
    s_nop 0
    v_mfma_f32_16x16x32_bf16 v[32:35], v[56:59], v[168:171], v[32:35]
    v_mfma_f32_16x16x32_bf16 v[36:39], v[56:59], v[172:175], v[36:39]
    v_mfma_f32_16x16x32_bf16 v[40:43], v[56:59], v[176:179], v[40:43]
    buffer_load_dwordx4 v[168:171], v2, s[24:27], s51 offen offset:0
    buffer_load_dwordx4 v[172:175], v2, s[24:27], s51 offen offset:128
    buffer_load_dwordx4 v[176:179], v2, s[24:27], s51 offen offset:256
    s_addk_i32 s51, 12288
    buffer_load_dwordx4 a[136:139], v5, s[16:19], s47 offen offset:128 nt
    buffer_load_dwordx4 a[140:143], v5, s[16:19], s47 offen offset:256 nt
    s_add_u32 s86, s86, 4
    s_cmp_ge_u32 s86, 63
    s_cselect_b32 s3, 63, 0
    s_cselect_b32 s4, 196608, 0
    s_sub_u32 s86, s86, s3
    s_add_u32 s87, s87, s4
    s_cmp_eq_u32 s87, s18
    s_cselect_b32 s87, 0, s87
    s_mul_i32 s3, s86, 49
    s_lshr_b32 s3, s3, 10
    s_mul_i32 s3, s3, 33408
    s_mul_i32 s47, s86, 1536
    s_add_u32 s3, s3, s87
    s_add_u32 s47, s47, s3
    buffer_load_dwordx4 a[144:147], v5, s[16:19], s47 offen offset:0 nt
    v_perm_b32 v15, v70, v70, s56
    v_and_b32 v52, v15, v16
    v_and_b32 v53, v15, v17
    v_and_b32 v54, v15, v18
    v_and_b32 v55, v15, v19
    s_waitcnt vmcnt(50)
    s_nop 0
    v_mfma_f32_16x16x32_bf16 v[32:35], v[52:55], v[180:183], v[32:35]
    v_mfma_f32_16x16x32_bf16 v[36:39], v[52:55], v[184:187], v[36:39]
    v_mfma_f32_16x16x32_bf16 v[40:43], v[52:55], v[188:191], v[40:43]
    buffer_load_dwordx4 v[180:183], v2, s[24:27], s51 offen offset:0
    buffer_load_dwordx4 v[184:187], v2, s[24:27], s51 offen offset:128
    buffer_load_dwordx4 v[188:191], v2, s[24:27], s51 offen offset:256
    s_addk_i32 s51, 12288
    buffer_load_dwordx4 a[148:151], v5, s[16:19], s47 offen offset:128 nt
    buffer_load_dwordx4 a[152:155], v5, s[16:19], s47 offen offset:256 nt
    s_add_u32 s86, s86, 4
    s_cmp_ge_u32 s86, 63
    s_cselect_b32 s3, 63, 0
    s_cselect_b32 s4, 196608, 0
    s_sub_u32 s86, s86, s3
    s_add_u32 s87, s87, s4
    s_cmp_eq_u32 s87, s18
    s_cselect_b32 s87, 0, s87
    s_mul_i32 s3, s86, 49
    s_lshr_b32 s3, s3, 10
    s_mul_i32 s3, s3, 33408
    s_mul_i32 s47, s86, 1536
    s_add_u32 s3, s3, s87
    s_add_u32 s47, s47, s3
    v_perm_b32 v15, v70, v70, s57
    v_and_b32 v56, v15, v16
    v_and_b32 v57, v15, v17
    v_and_b32 v58, v15, v18
    v_and_b32 v59, v15, v19
    s_waitcnt vmcnt(50)
    s_nop 0
    v_mfma_f32_16x16x32_bf16 v[32:35], v[56:59], v[192:195], v[32:35]
    v_mfma_f32_16x16x32_bf16 v[36:39], v[56:59], v[196:199], v[36:39]
    v_mfma_f32_16x16x32_bf16 v[40:43], v[56:59], v[200:203], v[40:43]
    buffer_load_dwordx4 v[192:195], v2, s[24:27], s51 offen offset:0
    buffer_load_dwordx4 v[196:199], v2, s[24:27], s51 offen offset:128
    buffer_load_dwordx4 v[200:203], v2, s[24:27], s51 offen offset:256
    s_addk_i32 s51, 12288
    buffer_load_dwordx4 a[156:159], v5, s[16:19], s47 offen offset:0 nt
    buffer_load_dwordx4 a[160:163], v5, s[16:19], s47 offen offset:128 nt
    buffer_load_dwordx4 a[164:167], v5, s[16:19], s47 offen offset:256 nt
    s_add_u32 s86, s86, 4
    s_cmp_ge_u32 s86, 63
    s_cselect_b32 s3, 63, 0
    s_cselect_b32 s4, 196608, 0
    s_sub_u32 s86, s86, s3
    s_add_u32 s87, s87, s4
    s_cmp_eq_u32 s87, s18
    s_cselect_b32 s87, 0, s87
    s_mul_i32 s3, s86, 49
    s_lshr_b32 s3, s3, 10
    s_mul_i32 s3, s3, 33408
    s_mul_i32 s47, s86, 1536
    s_add_u32 s3, s3, s87
    s_add_u32 s47, s47, s3
    v_perm_b32 v15, v71, v71, s56
    v_and_b32 v52, v15, v16
    v_and_b32 v53, v15, v17
    v_and_b32 v54, v15, v18
    v_and_b32 v55, v15, v19
    s_waitcnt vmcnt(51)
    s_nop 0
    v_mfma_f32_16x16x32_bf16 v[32:35], v[52:55], v[204:207], v[32:35]
    v_mfma_f32_16x16x32_bf16 v[36:39], v[52:55], v[208:211], v[36:39]
    v_mfma_f32_16x16x32_bf16 v[40:43], v[52:55], v[212:215], v[40:43]
    buffer_load_dwordx4 v[204:207], v2, s[24:27], s51 offen offset:0
    buffer_load_dwordx4 v[208:211], v2, s[24:27], s51 offen offset:128
    buffer_load_dwordx4 v[212:215], v2, s[24:27], s51 offen offset:256
    s_addk_i32 s51, 12288
    buffer_load_dwordx4 a[168:171], v5, s[16:19], s47 offen offset:0 nt
    buffer_load_dwordx4 a[172:175], v5, s[16:19], s47 offen offset:128 nt
    v_perm_b32 v15, v71, v71, s57
    v_and_b32 v56, v15, v16
    v_and_b32 v57, v15, v17
    v_and_b32 v58, v15, v18
    v_and_b32 v59, v15, v19
    s_waitcnt vmcnt(51)
    s_nop 0
    v_mfma_f32_16x16x32_bf16 v[32:35], v[56:59], v[216:219], v[32:35]
    v_mfma_f32_16x16x32_bf16 v[36:39], v[56:59], v[220:223], v[36:39]
    v_mfma_f32_16x16x32_bf16 v[40:43], v[56:59], v[224:227], v[40:43]
    buffer_load_dwordx4 v[216:219], v2, s[24:27], s51 offen offset:0
    buffer_load_dwordx4 v[220:223], v2, s[24:27], s51 offen offset:128
    buffer_load_dwordx4 v[224:227], v2, s[24:27], s51 offen offset:256
    s_addk_i32 s51, 12288
    buffer_load_dwordx4 a[176:179], v5, s[16:19], s47 offen offset:256 nt
    s_add_u32 s86, s86, 4
    s_cmp_ge_u32 s86, 63
    s_cselect_b32 s3, 63, 0
    s_cselect_b32 s4, 196608, 0
    s_sub_u32 s86, s86, s3
    s_add_u32 s87, s87, s4
    s_cmp_eq_u32 s87, s18
    s_cselect_b32 s87, 0, s87
    s_mul_i32 s3, s86, 49
    s_lshr_b32 s3, s3, 10
    s_mul_i32 s3, s3, 33408
    s_mul_i32 s47, s86, 1536
    s_add_u32 s3, s3, s87
    s_add_u32 s47, s47, s3
    buffer_load_dwordx4 a[180:183], v5, s[16:19], s47 offen offset:0 nt
    buffer_load_dwordx4 a[184:187], v5, s[16:19], s47 offen offset:128 nt
    v_perm_b32 v15, v72, v72, s56
    v_and_b32 v52, v15, v16
    v_and_b32 v53, v15, v17
    v_and_b32 v54, v15, v18
    v_and_b32 v55, v15, v19
    s_waitcnt vmcnt(52)
    s_nop 0
    v_mfma_f32_16x16x32_bf16 v[32:35], v[52:55], v[228:231], v[32:35]
    v_mfma_f32_16x16x32_bf16 v[36:39], v[52:55], v[232:235], v[36:39]
    v_mfma_f32_16x16x32_bf16 v[40:43], v[52:55], v[236:239], v[40:43]
    buffer_load_dwordx4 v[228:231], v2, s[24:27], s51 offen offset:0
    buffer_load_dwordx4 v[232:235], v2, s[24:27], s51 offen offset:128
    buffer_load_dwordx4 v[236:239], v2, s[24:27], s51 offen offset:256
    s_addk_i32 s51, 12288
    buffer_load_dwordx4 a[188:191], v5, s[16:19], s47 offen offset:256 nt
    s_add_u32 s86, s86, 4
    s_cmp_ge_u32 s86, 63
    s_cselect_b32 s3, 63, 0
    s_cselect_b32 s4, 196608, 0
    s_sub_u32 s86, s86, s3
    s_add_u32 s87, s87, s4
    s_cmp_eq_u32 s87, s18
    s_cselect_b32 s87, 0, s87
    s_mul_i32 s3, s86, 49
    s_lshr_b32 s3, s3, 10
    s_mul_i32 s3, s3, 33408
    s_mul_i32 s47, s86, 1536
    s_add_u32 s3, s3, s87
    s_add_u32 s47, s47, s3
    buffer_load_dwordx4 v[84:87], v5, s[16:19], s47 offen offset:0 nt
    v_perm_b32 v15, v72, v72, s57
    v_and_b32 v56, v15, v16
    v_and_b32 v57, v15, v17
    v_and_b32 v58, v15, v18
    v_and_b32 v59, v15, v19
    s_waitcnt vmcnt(52)
    s_nop 0
    v_mfma_f32_16x16x32_bf16 v[32:35], v[56:59], v[240:243], v[32:35]
    v_mfma_f32_16x16x32_bf16 v[36:39], v[56:59], v[244:247], v[36:39]
    v_mfma_f32_16x16x32_bf16 v[40:43], v[56:59], v[248:251], v[40:43]
    buffer_load_dwordx4 v[240:243], v2, s[24:27], s51 offen offset:0
    buffer_load_dwordx4 v[244:247], v2, s[24:27], s51 offen offset:128
    buffer_load_dwordx4 v[248:251], v2, s[24:27], s51 offen offset:256
    buffer_load_dwordx4 v[88:91], v5, s[16:19], s47 offen offset:128 nt
    buffer_load_dwordx4 v[92:95], v5, s[16:19], s47 offen offset:256 nt
    s_add_u32 s86, s86, 4
    s_cmp_ge_u32 s86, 63
    s_cselect_b32 s3, 63, 0
    s_cselect_b32 s4, 196608, 0
    s_sub_u32 s86, s86, s3
    s_add_u32 s87, s87, s4
    s_cmp_eq_u32 s87, s18
    s_cselect_b32 s87, 0, s87
    s_mul_i32 s3, s86, 49
    s_lshr_b32 s3, s3, 10
    s_mul_i32 s3, s3, 33408
    s_mul_i32 s47, s86, 1536
    s_add_u32 s3, s3, s87
    s_add_u32 s47, s47, s3
    buffer_load_dwordx4 v[96:99], v5, s[16:19], s47 offen offset:0 nt
    v_perm_b32 v15, v73, v73, s56
    v_and_b32 v52, v15, v16
    v_and_b32 v53, v15, v17
    v_and_b32 v54, v15, v18
    v_and_b32 v55, v15, v19
    s_waitcnt vmcnt(52)
    s_nop 0
    v_mfma_f32_16x16x32_bf16 v[32:35], v[52:55], v[132:135], v[32:35]
    v_mfma_f32_16x16x32_bf16 v[36:39], v[52:55], v[136:139], v[36:39]
    v_mfma_f32_16x16x32_bf16 v[40:43], v[52:55], v[140:143], v[40:43]
    buffer_load_dwordx4 v[100:103], v5, s[16:19], s47 offen offset:128 nt
    v_perm_b32 v15, v73, v73, s57
    v_and_b32 v56, v15, v16
    v_and_b32 v57, v15, v17
    v_and_b32 v58, v15, v18
    v_and_b32 v59, v15, v19
    s_waitcnt vmcnt(48)
    s_nop 0
    v_mfma_f32_16x16x32_bf16 v[32:35], v[56:59], v[144:147], v[32:35]
    v_mfma_f32_16x16x32_bf16 v[36:39], v[56:59], v[148:151], v[36:39]
    v_mfma_f32_16x16x32_bf16 v[40:43], v[56:59], v[152:155], v[40:43]
    buffer_load_dwordx4 v[104:107], v5, s[16:19], s47 offen offset:256 nt
    s_add_u32 s86, s86, 4
    s_cmp_ge_u32 s86, 63
    s_cselect_b32 s3, 63, 0
    s_cselect_b32 s4, 196608, 0
    s_sub_u32 s86, s86, s3
    s_add_u32 s87, s87, s4
    s_cmp_eq_u32 s87, s18
    s_cselect_b32 s87, 0, s87
    s_mul_i32 s3, s86, 49
    s_lshr_b32 s3, s3, 10
    s_mul_i32 s3, s3, 33408
    s_mul_i32 s47, s86, 1536
    s_add_u32 s3, s3, s87
    s_add_u32 s47, s47, s3
    v_perm_b32 v15, v74, v74, s56
    v_and_b32 v52, v15, v16
    v_and_b32 v53, v15, v17
    v_and_b32 v54, v15, v18
    v_and_b32 v55, v15, v19
    s_waitcnt vmcnt(43)
    s_nop 0
    v_mfma_f32_16x16x32_bf16 v[32:35], v[52:55], v[156:159], v[32:35]
    v_mfma_f32_16x16x32_bf16 v[36:39], v[52:55], v[160:163], v[36:39]
    v_mfma_f32_16x16x32_bf16 v[40:43], v[52:55], v[164:167], v[40:43]
    buffer_load_dwordx4 v[108:111], v5, s[16:19], s47 offen offset:0 nt
    v_perm_b32 v15, v74, v74, s57
    v_and_b32 v56, v15, v16
    v_and_b32 v57, v15, v17
    v_and_b32 v58, v15, v18
    v_and_b32 v59, v15, v19
    s_waitcnt vmcnt(39)
    s_nop 0
    v_mfma_f32_16x16x32_bf16 v[32:35], v[56:59], v[168:171], v[32:35]
    v_mfma_f32_16x16x32_bf16 v[36:39], v[56:59], v[172:175], v[36:39]
    v_mfma_f32_16x16x32_bf16 v[40:43], v[56:59], v[176:179], v[40:43]
    buffer_load_dwordx4 v[112:115], v5, s[16:19], s47 offen offset:128 nt
    v_perm_b32 v15, v75, v75, s56
    v_and_b32 v52, v15, v16
    v_and_b32 v53, v15, v17
    v_and_b32 v54, v15, v18
    v_and_b32 v55, v15, v19
    s_waitcnt vmcnt(34)
    s_nop 0
    v_mfma_f32_16x16x32_bf16 v[32:35], v[52:55], v[180:183], v[32:35]
    v_mfma_f32_16x16x32_bf16 v[36:39], v[52:55], v[184:187], v[36:39]
    v_mfma_f32_16x16x32_bf16 v[40:43], v[52:55], v[188:191], v[40:43]
    buffer_load_dwordx4 v[116:119], v5, s[16:19], s47 offen offset:256 nt
    s_add_u32 s86, s86, 4
    s_cmp_ge_u32 s86, 63
    s_cselect_b32 s3, 63, 0
    s_cselect_b32 s4, 196608, 0
    s_sub_u32 s86, s86, s3
    s_add_u32 s87, s87, s4
    s_cmp_eq_u32 s87, s18
    s_cselect_b32 s87, 0, s87
    s_mul_i32 s3, s86, 49
    s_lshr_b32 s3, s3, 10
    s_mul_i32 s3, s3, 33408
    s_mul_i32 s47, s86, 1536
    s_add_u32 s3, s3, s87
    s_add_u32 s47, s47, s3
    v_perm_b32 v15, v75, v75, s57
    v_and_b32 v56, v15, v16
    v_and_b32 v57, v15, v17
    v_and_b32 v58, v15, v18
    v_and_b32 v59, v15, v19
    s_waitcnt vmcnt(30)
    s_nop 0
    v_mfma_f32_16x16x32_bf16 v[32:35], v[56:59], v[192:195], v[32:35]
    v_mfma_f32_16x16x32_bf16 v[36:39], v[56:59], v[196:199], v[36:39]
    v_mfma_f32_16x16x32_bf16 v[40:43], v[56:59], v[200:203], v[40:43]
    buffer_load_dwordx4 v[120:123], v5, s[16:19], s47 offen offset:0 nt
    v_perm_b32 v15, v76, v76, s56
    v_and_b32 v52, v15, v16
    v_and_b32 v53, v15, v17
    v_and_b32 v54, v15, v18
    v_and_b32 v55, v15, v19
    s_waitcnt vmcnt(25)
    s_nop 0
    v_mfma_f32_16x16x32_bf16 v[32:35], v[52:55], v[204:207], v[32:35]
    v_mfma_f32_16x16x32_bf16 v[36:39], v[52:55], v[208:211], v[36:39]
    v_mfma_f32_16x16x32_bf16 v[40:43], v[52:55], v[212:215], v[40:43]
    buffer_load_dwordx4 v[124:127], v5, s[16:19], s47 offen offset:128 nt
    v_perm_b32 v15, v76, v76, s57
    v_and_b32 v56, v15, v16
    v_and_b32 v57, v15, v17
    v_and_b32 v58, v15, v18
    v_and_b32 v59, v15, v19
    s_waitcnt vmcnt(21)
    s_nop 0
    v_mfma_f32_16x16x32_bf16 v[32:35], v[56:59], v[216:219], v[32:35]
    v_mfma_f32_16x16x32_bf16 v[36:39], v[56:59], v[220:223], v[36:39]
    v_mfma_f32_16x16x32_bf16 v[40:43], v[56:59], v[224:227], v[40:43]
    buffer_load_dwordx4 v[128:131], v5, s[16:19], s47 offen offset:256 nt
    s_add_u32 s86, s86, 4
    s_cmp_ge_u32 s86, 63
    s_cselect_b32 s3, 63, 0
    s_cselect_b32 s4, 196608, 0
    s_sub_u32 s86, s86, s3
    s_add_u32 s87, s87, s4
    s_cmp_eq_u32 s87, s18
    s_cselect_b32 s87, 0, s87
    s_mul_i32 s3, s86, 49
    s_lshr_b32 s3, s3, 10
    s_mul_i32 s3, s3, 33408
    s_mul_i32 s47, s86, 1536
    s_add_u32 s3, s3, s87
    s_add_u32 s47, s47, s3
    v_perm_b32 v15, v77, v77, s56
    v_and_b32 v52, v15, v16
    v_and_b32 v53, v15, v17
    v_and_b32 v54, v15, v18
    v_and_b32 v55, v15, v19
    s_waitcnt vmcnt(16)
    s_nop 0
    v_mfma_f32_16x16x32_bf16 v[32:35], v[52:55], v[228:231], v[32:35]
    v_mfma_f32_16x16x32_bf16 v[36:39], v[52:55], v[232:235], v[36:39]
    v_mfma_f32_16x16x32_bf16 v[40:43], v[52:55], v[236:239], v[40:43]
    v_perm_b32 v15, v77, v77, s57
    v_and_b32 v56, v15, v16
    v_and_b32 v57, v15, v17
    v_and_b32 v58, v15, v18
    v_and_b32 v59, v15, v19
    s_waitcnt vmcnt(11)
    s_nop 0
    v_mfma_f32_16x16x32_bf16 v[32:35], v[56:59], v[240:243], v[32:35]
    v_mfma_f32_16x16x32_bf16 v[36:39], v[56:59], v[244:247], v[36:39]
    v_mfma_f32_16x16x32_bf16 v[40:43], v[56:59], v[248:251], v[40:43]
    s_nop 7
    s_nop 1
    s_mov_b32 exec_lo, 0x00ff00ff
    s_mov_b32 exec_hi, 0xff00ff00
    ds_write_b128 v78, v[32:35] offset:0
    ds_write_b128 v78, v[36:39] offset:256
    ds_write_b128 v78, v[40:43] offset:512
    s_mov_b64 exec, -1
    s_waitcnt lgkmcnt(0)
    s_barrier
    v_lshlrev_b32 v8, 4, v1
    ds_read_b128 v[132:135], v8 offset:0
    ds_read_b128 v[136:139], v8 offset:768
    ds_read_b128 v[140:143], v8 offset:1536
    ds_read_b128 v[144:147], v8 offset:2304
    ds_read_b128 v[148:151], v8 offset:3072
    ds_read_b128 v[152:155], v8 offset:3840
    ds_read_b128 v[156:159], v8 offset:4608
    ds_read_b128 v[160:163], v8 offset:5376
    v_lshlrev_b32 v8, 3, v1
    v_lshl_add_u32 v8, v7, 9, v8
    v_bfe_u32 v14, v1, 4, 1
    v_lshlrev_b32 v14, 6, v14
    v_and_b32 v15, 3, v1
    v_lshl_add_u32 v14, v15, 4, v14
    v_lshl_add_u32 v14, v7, 9, v14
    s_waitcnt lgkmcnt(6)
    v_pk_add_f32 v[132:133], v[132:133], v[136:137]
    v_pk_add_f32 v[134:135], v[134:135], v[138:139]
    s_waitcnt lgkmcnt(5)
    v_pk_add_f32 v[132:133], v[132:133], v[140:141]
    v_pk_add_f32 v[134:135], v[134:135], v[142:143]
    s_waitcnt lgkmcnt(4)
    v_pk_add_f32 v[132:133], v[132:133], v[144:145]
    v_pk_add_f32 v[134:135], v[134:135], v[146:147]
    s_waitcnt lgkmcnt(3)
    v_pk_add_f32 v[132:133], v[132:133], v[148:149]
    v_pk_add_f32 v[134:135], v[134:135], v[150:151]
    s_waitcnt lgkmcnt(2)
    v_pk_add_f32 v[132:133], v[132:133], v[152:153]
    v_pk_add_f32 v[134:135], v[134:135], v[154:155]
    s_waitcnt lgkmcnt(1)
    v_pk_add_f32 v[132:133], v[132:133], v[156:157]
    v_pk_add_f32 v[134:135], v[134:135], v[158:159]
    s_waitcnt lgkmcnt(0)
    v_pk_add_f32 v[132:133], v[132:133], v[160:161]
    v_pk_add_f32 v[134:135], v[134:135], v[162:163]
    v_cvt_pk_bf16_f32 v136, v132, v133
    v_cvt_pk_bf16_f32 v137, v134, v135
    ds_write_b64 v8, v[136:137] offset:6144
    ds_read_b128 v[20:23], v14 offset:6144
    ds_read_b128 v[24:27], v14 offset:6272
    ds_read_b128 v[28:31], v14 offset:6400
    v_bfe_u32 v11, v1, 2, 2
    v_lshrrev_b32 v13, 5, v1
    v_mul_u32_u24 v12, 32640, v13
    v_sub_u32 v76, v5, v12
    v_mul_u32_u24 v12, 384, v11
    v_sub_u32 v76, v76, v12
    v_lshl_add_u32 v11, v13, 2, v11
    v_add_u32 v13, 1, v11
    v_mul_u32_u24 v13, 11, v13
    v_lshrrev_b32 v13, 5, v13
    v_sub_u32 v13, 1, v13
    v_mul_i32_i24 v13, 32256, v13
    v_mul_u32_u24 v11, 32640, v11
    v_add3_u32 v76, v76, v11, v13
    v_lshrrev_b32 v11, 4, v1
    v_bfe_u32 v13, v1, 3, 1
    v_mul_u32_u24 v12, 32640, v13
    v_sub_u32 v77, v6, v12
    v_mul_u32_u24 v12, 384, v11
    v_sub_u32 v77, v77, v12
    v_lshl_add_u32 v11, v13, 2, v11
    v_add_u32 v13, 1, v11
    v_mul_u32_u24 v13, 11, v13
    v_lshrrev_b32 v13, 5, v13
    v_sub_u32 v13, 1, v13
    v_mul_i32_i24 v13, 32256, v13
    v_mul_u32_u24 v11, 32640, v11
    v_add3_u32 v77, v77, v11, v13
    s_mul_i32 s94, s13, 196608
    s_add_u32 s3, s94, 786432
    s_xor_b32 s95, s94, s3
    s_cmp_lg_u32 s13, 0
    s_cbranch_scc1 L_nonce2
    s_cmp_eq_u32 s96, 0
    s_cselect_b32 s96, s81, s96
    s_mul_i32 s96, s96, 0x9e3779b1
    v_mov_b32 v11, 8244
    v_mov_b32 v13, s96
    ds_write_b32 v11, v13
L_nonce2:
    s_mov_b32 s76, 0
    s_mov_b32 s77, -1
    s_movk_i32 s79, -100
    v_lshlrev_b32 v73, 2, v1
    v_and_b32 v73, 127, v73
    v_add_u32 v73, 2097152, v73
    s_waitcnt lgkmcnt(0)
    s_mov_b32 exec_lo, 0xff00ff00
    s_mov_b32 exec_hi, 0x00ff00ff
    v_mov_b32 v20, 0
    v_mov_b32 v21, 0
    v_mov_b32 v22, 0
    v_mov_b32 v23, 0
    v_mov_b32 v24, 0
    v_mov_b32 v25, 0
    v_mov_b32 v26, 0
    v_mov_b32 v27, 0
    v_mov_b32 v28, 0
    v_mov_b32 v29, 0
    v_mov_b32 v30, 0
    v_mov_b32 v31, 0
    s_mov_b64 exec, -1
    s_nop 1
    v_mfma_f32_16x16x32_bf16 v[32:35], a[0:3], v[20:23], 0
    v_mfma_f32_16x16x32_bf16 v[32:35], a[4:7], v[24:27], v[32:35]
    v_mfma_f32_16x16x32_bf16 v[32:35], a[8:11], v[28:31], v[32:35]
    v_mfma_f32_16x16x32_bf16 v[36:39], a[12:15], v[20:23], 0
    v_mfma_f32_16x16x32_bf16 v[36:39], a[16:19], v[24:27], v[36:39]
    v_mfma_f32_16x16x32_bf16 v[36:39], a[20:23], v[28:31], v[36:39]
    s_nop 4
    v_mov_b32_dpp v14, v32 quad_perm:[0,0,0,0] row_mask:0xf bank_mask:0xf
    v_add_f32_dpp v14, v33, v14 quad_perm:[1,1,1,1] row_mask:0xf bank_mask:0xf
    v_add_f32_dpp v14, v34, v14 quad_perm:[2,2,2,2] row_mask:0xf bank_mask:0xf
    v_add_f32_dpp v14, v35, v14 quad_perm:[3,3,3,3] row_mask:0xf bank_mask:0xf
    ds_write_b32 v80, v14 offset:0
    v_mfma_f32_16x16x32_bf16 v[32:35], a[24:27], v[20:23], 0
    v_mfma_f32_16x16x32_bf16 v[32:35], a[28:31], v[24:27], v[32:35]
    v_mfma_f32_16x16x32_bf16 v[32:35], a[32:35], v[28:31], v[32:35]
    v_mov_b32_dpp v14, v36 quad_perm:[0,0,0,0] row_mask:0xf bank_mask:0xf
    v_add_f32_dpp v14, v37, v14 quad_perm:[1,1,1,1] row_mask:0xf bank_mask:0xf
    v_add_f32_dpp v14, v38, v14 quad_perm:[2,2,2,2] row_mask:0xf bank_mask:0xf
    v_add_f32_dpp v14, v39, v14 quad_perm:[3,3,3,3] row_mask:0xf bank_mask:0xf
    ds_write_b32 v80, v14 offset:4
    v_mfma_f32_16x16x32_bf16 v[36:39], a[36:39], v[20:23], 0
    v_mfma_f32_16x16x32_bf16 v[36:39], a[40:43], v[24:27], v[36:39]
    v_mfma_f32_16x16x32_bf16 v[36:39], a[44:47], v[28:31], v[36:39]
    v_mov_b32_dpp v14, v32 quad_perm:[0,0,0,0] row_mask:0xf bank_mask:0xf
    v_add_f32_dpp v14, v33, v14 quad_perm:[1,1,1,1] row_mask:0xf bank_mask:0xf
    v_add_f32_dpp v14, v34, v14 quad_perm:[2,2,2,2] row_mask:0xf bank_mask:0xf
    v_add_f32_dpp v14, v35, v14 quad_perm:[3,3,3,3] row_mask:0xf bank_mask:0xf
    ds_write_b32 v80, v14 offset:8
    s_waitcnt vmcnt(5)
    v_mfma_f32_16x16x32_bf16 v[44:47], v[84:87], v[20:23], 0
    buffer_load_dwordx4 v[84:87], v5, s[16:19], s47 offen offset:0 nt
    s_waitcnt vmcnt(5)
    v_mfma_f32_16x16x32_bf16 v[44:47], v[88:91], v[24:27], v[44:47]
    buffer_load_dwordx4 v[88:91], v5, s[16:19], s47 offen offset:128 nt
    s_waitcnt vmcnt(5)
    v_mfma_f32_16x16x32_bf16 v[44:47], v[92:95], v[28:31], v[44:47]
    buffer_load_dwordx4 v[92:95], v5, s[16:19], s47 offen offset:256 nt
    s_add_u32 s86, s86, 4
    s_cmp_ge_u32 s86, 63
    s_cselect_b32 s3, 63, 0
    s_cselect_b32 s4, 196608, 0
    s_sub_u32 s86, s86, s3
    s_add_u32 s87, s87, s4
    s_cmp_eq_u32 s87, s18
    s_cselect_b32 s87, 0, s87
    s_mul_i32 s3, s86, 49
    s_lshr_b32 s3, s3, 10
    s_mul_i32 s3, s3, 33408
    s_mul_i32 s47, s86, 1536
    s_add_u32 s3, s3, s87
    s_add_u32 s47, s47, s3
    v_mfma_f32_16x16x32_bf16 v[32:35], a[48:51], v[20:23], 0
    v_mfma_f32_16x16x32_bf16 v[32:35], a[52:55], v[24:27], v[32:35]
    v_mfma_f32_16x16x32_bf16 v[32:35], a[56:59], v[28:31], v[32:35]
    v_mov_b32_dpp v14, v36 quad_perm:[0,0,0,0] row_mask:0xf bank_mask:0xf
    v_add_f32_dpp v14, v37, v14 quad_perm:[1,1,1,1] row_mask:0xf bank_mask:0xf
    v_add_f32_dpp v14, v38, v14 quad_perm:[2,2,2,2] row_mask:0xf bank_mask:0xf
    v_add_f32_dpp v14, v39, v14 quad_perm:[3,3,3,3] row_mask:0xf bank_mask:0xf
    ds_write_b32 v80, v14 offset:12
    v_mfma_f32_16x16x32_bf16 v[36:39], a[60:63], v[20:23], 0
    v_mfma_f32_16x16x32_bf16 v[36:39], a[64:67], v[24:27], v[36:39]
    v_mfma_f32_16x16x32_bf16 v[36:39], a[68:71], v[28:31], v[36:39]
    v_mov_b32_dpp v14, v32 quad_perm:[0,0,0,0] row_mask:0xf bank_mask:0xf
    v_add_f32_dpp v14, v33, v14 quad_perm:[1,1,1,1] row_mask:0xf bank_mask:0xf
    v_add_f32_dpp v14, v34, v14 quad_perm:[2,2,2,2] row_mask:0xf bank_mask:0xf
    v_add_f32_dpp v14, v35, v14 quad_perm:[3,3,3,3] row_mask:0xf bank_mask:0xf
    ds_write_b32 v80, v14 offset:16
    s_waitcnt vmcnt(5)
    v_mfma_f32_16x16x32_bf16 v[48:51], v[96:99], v[20:23], 0
    buffer_load_dwordx4 v[96:99], v5, s[16:19], s47 offen offset:0 nt
    s_waitcnt vmcnt(5)
    v_mfma_f32_16x16x32_bf16 v[48:51], v[100:103], v[24:27], v[48:51]
    buffer_load_dwordx4 v[100:103], v5, s[16:19], s47 offen offset:128 nt
    s_waitcnt vmcnt(5)
    v_mfma_f32_16x16x32_bf16 v[48:51], v[104:107], v[28:31], v[48:51]
    buffer_load_dwordx4 v[104:107], v5, s[16:19], s47 offen offset:256 nt
    s_add_u32 s86, s86, 4
    s_cmp_ge_u32 s86, 63
    s_cselect_b32 s3, 63, 0
    s_cselect_b32 s4, 196608, 0
    s_sub_u32 s86, s86, s3
    s_add_u32 s87, s87, s4
    s_cmp_eq_u32 s87, s18
    s_cselect_b32 s87, 0, s87
    s_mul_i32 s3, s86, 49
    s_lshr_b32 s3, s3, 10
    s_mul_i32 s3, s3, 33408
    s_mul_i32 s47, s86, 1536
    s_add_u32 s3, s3, s87
    s_add_u32 s47, s47, s3
    v_mov_b32_dpp v14, v44 quad_perm:[0,0,0,0] row_mask:0xf bank_mask:0xf
    v_add_f32_dpp v14, v45, v14 quad_perm:[1,1,1,1] row_mask:0xf bank_mask:0xf
    v_add_f32_dpp v14, v46, v14 quad_perm:[2,2,2,2] row_mask:0xf bank_mask:0xf
    v_add_f32_dpp v14, v47, v14 quad_perm:[3,3,3,3] row_mask:0xf bank_mask:0xf
    ds_write_b32 v80, v14 offset:64
    v_mfma_f32_16x16x32_bf16 v[32:35], a[72:75], v[20:23], 0
    v_mfma_f32_16x16x32_bf16 v[32:35], a[76:79], v[24:27], v[32:35]
    v_mfma_f32_16x16x32_bf16 v[32:35], a[80:83], v[28:31], v[32:35]
    v_mov_b32_dpp v14, v36 quad_perm:[0,0,0,0] row_mask:0xf bank_mask:0xf
    v_add_f32_dpp v14, v37, v14 quad_perm:[1,1,1,1] row_mask:0xf bank_mask:0xf
    v_add_f32_dpp v14, v38, v14 quad_perm:[2,2,2,2] row_mask:0xf bank_mask:0xf
    v_add_f32_dpp v14, v39, v14 quad_perm:[3,3,3,3] row_mask:0xf bank_mask:0xf
    ds_write_b32 v80, v14 offset:20
    v_mfma_f32_16x16x32_bf16 v[36:39], a[84:87], v[20:23], 0
    v_mfma_f32_16x16x32_bf16 v[36:39], a[88:91], v[24:27], v[36:39]
    v_mfma_f32_16x16x32_bf16 v[36:39], a[92:95], v[28:31], v[36:39]
    v_mov_b32_dpp v14, v32 quad_perm:[0,0,0,0] row_mask:0xf bank_mask:0xf
    v_add_f32_dpp v14, v33, v14 quad_perm:[1,1,1,1] row_mask:0xf bank_mask:0xf
    v_add_f32_dpp v14, v34, v14 quad_perm:[2,2,2,2] row_mask:0xf bank_mask:0xf
    v_add_f32_dpp v14, v35, v14 quad_perm:[3,3,3,3] row_mask:0xf bank_mask:0xf
    ds_write_b32 v80, v14 offset:24
    s_waitcnt vmcnt(5)
    v_mfma_f32_16x16x32_bf16 v[44:47], v[108:111], v[20:23], 0
    buffer_load_dwordx4 v[108:111], v5, s[16:19], s47 offen offset:0 nt
    s_waitcnt vmcnt(5)
    v_mfma_f32_16x16x32_bf16 v[44:47], v[112:115], v[24:27], v[44:47]
    buffer_load_dwordx4 v[112:115], v5, s[16:19], s47 offen offset:128 nt
    s_waitcnt vmcnt(5)
    v_mfma_f32_16x16x32_bf16 v[44:47], v[116:119], v[28:31], v[44:47]
    buffer_load_dwordx4 v[116:119], v5, s[16:19], s47 offen offset:256 nt
    s_add_u32 s86, s86, 4
    s_cmp_ge_u32 s86, 63
    s_cselect_b32 s3, 63, 0
    s_cselect_b32 s4, 196608, 0
    s_sub_u32 s86, s86, s3
    s_add_u32 s87, s87, s4
    s_cmp_eq_u32 s87, s18
    s_cselect_b32 s87, 0, s87
    s_mul_i32 s3, s86, 49
    s_lshr_b32 s3, s3, 10
    s_mul_i32 s3, s3, 33408
    s_mul_i32 s47, s86, 1536
    s_add_u32 s3, s3, s87
    s_add_u32 s47, s47, s3
    v_mov_b32_dpp v14, v48 quad_perm:[0,0,0,0] row_mask:0xf bank_mask:0xf
    v_add_f32_dpp v14, v49, v14 quad_perm:[1,1,1,1] row_mask:0xf bank_mask:0xf
    v_add_f32_dpp v14, v50, v14 quad_perm:[2,2,2,2] row_mask:0xf bank_mask:0xf
    v_add_f32_dpp v14, v51, v14 quad_perm:[3,3,3,3] row_mask:0xf bank_mask:0xf
    ds_write_b32 v80, v14 offset:68
    v_mfma_f32_16x16x32_bf16 v[32:35], a[96:99], v[20:23], 0
    v_mfma_f32_16x16x32_bf16 v[32:35], a[100:103], v[24:27], v[32:35]
    v_mfma_f32_16x16x32_bf16 v[32:35], a[104:107], v[28:31], v[32:35]
    v_mov_b32_dpp v14, v36 quad_perm:[0,0,0,0] row_mask:0xf bank_mask:0xf
    v_add_f32_dpp v14, v37, v14 quad_perm:[1,1,1,1] row_mask:0xf bank_mask:0xf
    v_add_f32_dpp v14, v38, v14 quad_perm:[2,2,2,2] row_mask:0xf bank_mask:0xf
    v_add_f32_dpp v14, v39, v14 quad_perm:[3,3,3,3] row_mask:0xf bank_mask:0xf
    ds_write_b32 v80, v14 offset:28
    v_mfma_f32_16x16x32_bf16 v[36:39], a[108:111], v[20:23], 0
    v_mfma_f32_16x16x32_bf16 v[36:39], a[112:115], v[24:27], v[36:39]
    v_mfma_f32_16x16x32_bf16 v[36:39], a[116:119], v[28:31], v[36:39]
    v_mov_b32_dpp v14, v32 quad_perm:[0,0,0,0] row_mask:0xf bank_mask:0xf
    v_add_f32_dpp v14, v33, v14 quad_perm:[1,1,1,1] row_mask:0xf bank_mask:0xf
    v_add_f32_dpp v14, v34, v14 quad_perm:[2,2,2,2] row_mask:0xf bank_mask:0xf
    v_add_f32_dpp v14, v35, v14 quad_perm:[3,3,3,3] row_mask:0xf bank_mask:0xf
    ds_write_b32 v80, v14 offset:32
    s_waitcnt vmcnt(5)
    v_mfma_f32_16x16x32_bf16 v[48:51], v[120:123], v[20:23], 0
    buffer_load_dwordx4 v[120:123], v5, s[16:19], s47 offen offset:0 nt
    s_waitcnt vmcnt(5)
    v_mfma_f32_16x16x32_bf16 v[48:51], v[124:127], v[24:27], v[48:51]
    buffer_load_dwordx4 v[124:127], v5, s[16:19], s47 offen offset:128 nt
    s_waitcnt vmcnt(5)
    v_mfma_f32_16x16x32_bf16 v[48:51], v[128:131], v[28:31], v[48:51]
    buffer_load_dwordx4 v[128:131], v5, s[16:19], s47 offen offset:256 nt
    s_add_u32 s86, s86, 4
    s_cmp_ge_u32 s86, 63
    s_cselect_b32 s3, 63, 0
    s_cselect_b32 s4, 196608, 0
    s_sub_u32 s86, s86, s3
    s_add_u32 s87, s87, s4
    s_cmp_eq_u32 s87, s18
    s_cselect_b32 s87, 0, s87
    s_mul_i32 s3, s86, 49
    s_lshr_b32 s3, s3, 10
    s_mul_i32 s3, s3, 33408
    s_mul_i32 s47, s86, 1536
    s_add_u32 s3, s3, s87
    s_add_u32 s47, s47, s3
    v_mov_b32_dpp v14, v44 quad_perm:[0,0,0,0] row_mask:0xf bank_mask:0xf
    v_add_f32_dpp v14, v45, v14 quad_perm:[1,1,1,1] row_mask:0xf bank_mask:0xf
    v_add_f32_dpp v14, v46, v14 quad_perm:[2,2,2,2] row_mask:0xf bank_mask:0xf
    v_add_f32_dpp v14, v47, v14 quad_perm:[3,3,3,3] row_mask:0xf bank_mask:0xf
    ds_write_b32 v80, v14 offset:72
    v_mfma_f32_16x16x32_bf16 v[32:35], a[120:123], v[20:23], 0
    v_mfma_f32_16x16x32_bf16 v[32:35], a[124:127], v[24:27], v[32:35]
    v_mfma_f32_16x16x32_bf16 v[32:35], a[128:131], v[28:31], v[32:35]
    v_mov_b32_dpp v14, v36 quad_perm:[0,0,0,0] row_mask:0xf bank_mask:0xf
    v_add_f32_dpp v14, v37, v14 quad_perm:[1,1,1,1] row_mask:0xf bank_mask:0xf
    v_add_f32_dpp v14, v38, v14 quad_perm:[2,2,2,2] row_mask:0xf bank_mask:0xf
    v_add_f32_dpp v14, v39, v14 quad_perm:[3,3,3,3] row_mask:0xf bank_mask:0xf
    ds_write_b32 v80, v14 offset:36
    v_mfma_f32_16x16x32_bf16 v[36:39], a[132:135], v[20:23], 0
    v_mfma_f32_16x16x32_bf16 v[36:39], a[136:139], v[24:27], v[36:39]
    v_mfma_f32_16x16x32_bf16 v[36:39], a[140:143], v[28:31], v[36:39]
    v_mov_b32_dpp v14, v32 quad_perm:[0,0,0,0] row_mask:0xf bank_mask:0xf
    v_add_f32_dpp v14, v33, v14 quad_perm:[1,1,1,1] row_mask:0xf bank_mask:0xf
    v_add_f32_dpp v14, v34, v14 quad_perm:[2,2,2,2] row_mask:0xf bank_mask:0xf
    v_add_f32_dpp v14, v35, v14 quad_perm:[3,3,3,3] row_mask:0xf bank_mask:0xf
    ds_write_b32 v80, v14 offset:40
    s_waitcnt vmcnt(5)
    v_mfma_f32_16x16x32_bf16 v[44:47], v[84:87], v[20:23], 0
    buffer_load_dwordx4 v[84:87], v5, s[16:19], s47 offen offset:0 nt
    s_waitcnt vmcnt(5)
    v_mfma_f32_16x16x32_bf16 v[44:47], v[88:91], v[24:27], v[44:47]
    buffer_load_dwordx4 v[88:91], v5, s[16:19], s47 offen offset:128 nt
    s_waitcnt vmcnt(5)
    v_mfma_f32_16x16x32_bf16 v[44:47], v[92:95], v[28:31], v[44:47]
    buffer_load_dwordx4 v[92:95], v5, s[16:19], s47 offen offset:256 nt
    s_add_u32 s86, s86, 4
    s_cmp_ge_u32 s86, 63
    s_cselect_b32 s3, 63, 0
    s_cselect_b32 s4, 196608, 0
    s_sub_u32 s86, s86, s3
    s_add_u32 s87, s87, s4
    s_cmp_eq_u32 s87, s18
    s_cselect_b32 s87, 0, s87
    s_mul_i32 s3, s86, 49
    s_lshr_b32 s3, s3, 10
    s_mul_i32 s3, s3, 33408
    s_mul_i32 s47, s86, 1536
    s_add_u32 s3, s3, s87
    s_add_u32 s47, s47, s3
    v_mov_b32_dpp v14, v48 quad_perm:[0,0,0,0] row_mask:0xf bank_mask:0xf
    v_add_f32_dpp v14, v49, v14 quad_perm:[1,1,1,1] row_mask:0xf bank_mask:0xf
    v_add_f32_dpp v14, v50, v14 quad_perm:[2,2,2,2] row_mask:0xf bank_mask:0xf
    v_add_f32_dpp v14, v51, v14 quad_perm:[3,3,3,3] row_mask:0xf bank_mask:0xf
    ds_write_b32 v80, v14 offset:76
    v_mfma_f32_16x16x32_bf16 v[32:35], a[144:147], v[20:23], 0
    v_mfma_f32_16x16x32_bf16 v[32:35], a[148:151], v[24:27], v[32:35]
    v_mfma_f32_16x16x32_bf16 v[32:35], a[152:155], v[28:31], v[32:35]
    v_mov_b32_dpp v14, v36 quad_perm:[0,0,0,0] row_mask:0xf bank_mask:0xf
    v_add_f32_dpp v14, v37, v14 quad_perm:[1,1,1,1] row_mask:0xf bank_mask:0xf
    v_add_f32_dpp v14, v38, v14 quad_perm:[2,2,2,2] row_mask:0xf bank_mask:0xf
    v_add_f32_dpp v14, v39, v14 quad_perm:[3,3,3,3] row_mask:0xf bank_mask:0xf
    ds_write_b32 v80, v14 offset:44
    s_waitcnt vmcnt(5)
    v_mfma_f32_16x16x32_bf16 v[48:51], v[96:99], v[20:23], 0
    buffer_load_dwordx4 v[96:99], v5, s[16:19], s47 offen offset:0 nt
    s_waitcnt vmcnt(5)
    v_mfma_f32_16x16x32_bf16 v[48:51], v[100:103], v[24:27], v[48:51]
    buffer_load_dwordx4 v[100:103], v5, s[16:19], s47 offen offset:128 nt
    s_waitcnt vmcnt(5)
    v_mfma_f32_16x16x32_bf16 v[48:51], v[104:107], v[28:31], v[48:51]
    buffer_load_dwordx4 v[104:107], v5, s[16:19], s47 offen offset:256 nt
    s_add_u32 s86, s86, 4
    s_cmp_ge_u32 s86, 63
    s_cselect_b32 s3, 63, 0
    s_cselect_b32 s4, 196608, 0
    s_sub_u32 s86, s86, s3
    s_add_u32 s87, s87, s4
    s_cmp_eq_u32 s87, s18
    s_cselect_b32 s87, 0, s87
    s_mul_i32 s3, s86, 49
    s_lshr_b32 s3, s3, 10
    s_mul_i32 s3, s3, 33408
    s_mul_i32 s47, s86, 1536
    s_add_u32 s3, s3, s87
    s_add_u32 s47, s47, s3
    v_mov_b32_dpp v14, v44 quad_perm:[0,0,0,0] row_mask:0xf bank_mask:0xf
    v_add_f32_dpp v14, v45, v14 quad_perm:[1,1,1,1] row_mask:0xf bank_mask:0xf
    v_add_f32_dpp v14, v46, v14 quad_perm:[2,2,2,2] row_mask:0xf bank_mask:0xf
    v_add_f32_dpp v14, v47, v14 quad_perm:[3,3,3,3] row_mask:0xf bank_mask:0xf
    ds_write_b32 v80, v14 offset:80
    v_mfma_f32_16x16x32_bf16 v[36:39], a[156:159], v[20:23], 0
    v_mfma_f32_16x16x32_bf16 v[36:39], a[160:163], v[24:27], v[36:39]
    v_mfma_f32_16x16x32_bf16 v[36:39], a[164:167], v[28:31], v[36:39]
    v_mov_b32_dpp v14, v32 quad_perm:[0,0,0,0] row_mask:0xf bank_mask:0xf
    v_add_f32_dpp v14, v33, v14 quad_perm:[1,1,1,1] row_mask:0xf bank_mask:0xf
    v_add_f32_dpp v14, v34, v14 quad_perm:[2,2,2,2] row_mask:0xf bank_mask:0xf
    v_add_f32_dpp v14, v35, v14 quad_perm:[3,3,3,3] row_mask:0xf bank_mask:0xf
    ds_write_b32 v80, v14 offset:48
    s_waitcnt vmcnt(5)
    v_mfma_f32_16x16x32_bf16 v[44:47], v[108:111], v[20:23], 0
    buffer_load_dwordx4 v[108:111], v5, s[16:19], s47 offen offset:0 nt
    s_waitcnt vmcnt(5)
    v_mfma_f32_16x16x32_bf16 v[44:47], v[112:115], v[24:27], v[44:47]
    buffer_load_dwordx4 v[112:115], v5, s[16:19], s47 offen offset:128 nt
    s_waitcnt vmcnt(5)
    v_mfma_f32_16x16x32_bf16 v[44:47], v[116:119], v[28:31], v[44:47]
    buffer_load_dwordx4 v[116:119], v5, s[16:19], s47 offen offset:256 nt
    s_add_u32 s86, s86, 4
    s_cmp_ge_u32 s86, 63
    s_cselect_b32 s3, 63, 0
    s_cselect_b32 s4, 196608, 0
    s_sub_u32 s86, s86, s3
    s_add_u32 s87, s87, s4
    s_cmp_eq_u32 s87, s18
    s_cselect_b32 s87, 0, s87
    s_mul_i32 s3, s86, 49
    s_lshr_b32 s3, s3, 10
    s_mul_i32 s3, s3, 33408
    s_mul_i32 s47, s86, 1536
    s_add_u32 s3, s3, s87
    s_add_u32 s47, s47, s3
    v_mov_b32_dpp v14, v48 quad_perm:[0,0,0,0] row_mask:0xf bank_mask:0xf
    v_add_f32_dpp v14, v49, v14 quad_perm:[1,1,1,1] row_mask:0xf bank_mask:0xf
    v_add_f32_dpp v14, v50, v14 quad_perm:[2,2,2,2] row_mask:0xf bank_mask:0xf
    v_add_f32_dpp v14, v51, v14 quad_perm:[3,3,3,3] row_mask:0xf bank_mask:0xf
    ds_write_b32 v80, v14 offset:84
    v_mfma_f32_16x16x32_bf16 v[32:35], a[168:171], v[20:23], 0
    v_mfma_f32_16x16x32_bf16 v[32:35], a[172:175], v[24:27], v[32:35]
    v_mfma_f32_16x16x32_bf16 v[32:35], a[176:179], v[28:31], v[32:35]
    v_mov_b32_dpp v14, v36 quad_perm:[0,0,0,0] row_mask:0xf bank_mask:0xf
    v_add_f32_dpp v14, v37, v14 quad_perm:[1,1,1,1] row_mask:0xf bank_mask:0xf
    v_add_f32_dpp v14, v38, v14 quad_perm:[2,2,2,2] row_mask:0xf bank_mask:0xf
    v_add_f32_dpp v14, v39, v14 quad_perm:[3,3,3,3] row_mask:0xf bank_mask:0xf
    ds_write_b32 v80, v14 offset:52
    s_waitcnt vmcnt(5)
    v_mfma_f32_16x16x32_bf16 v[48:51], v[120:123], v[20:23], 0
    buffer_load_dwordx4 v[120:123], v5, s[16:19], s47 offen offset:0 nt
    s_waitcnt vmcnt(5)
    v_mfma_f32_16x16x32_bf16 v[48:51], v[124:127], v[24:27], v[48:51]
    buffer_load_dwordx4 v[124:127], v5, s[16:19], s47 offen offset:128 nt
    s_waitcnt vmcnt(5)
    v_mfma_f32_16x16x32_bf16 v[48:51], v[128:131], v[28:31], v[48:51]
    buffer_load_dwordx4 v[128:131], v5, s[16:19], s47 offen offset:256 nt
    s_add_u32 s86, s86, 4
    s_cmp_ge_u32 s86, 63
    s_cselect_b32 s3, 63, 0
    s_cselect_b32 s4, 196608, 0
    s_sub_u32 s86, s86, s3
    s_add_u32 s87, s87, s4
    s_cmp_eq_u32 s87, s18
    s_cselect_b32 s87, 0, s87
    s_mul_i32 s3, s86, 49
    s_lshr_b32 s3, s3, 10
    s_mul_i32 s3, s3, 33408
    s_mul_i32 s47, s86, 1536
    s_add_u32 s3, s3, s87
    s_add_u32 s47, s47, s3
    v_mov_b32_dpp v14, v44 quad_perm:[0,0,0,0] row_mask:0xf bank_mask:0xf
    v_add_f32_dpp v14, v45, v14 quad_perm:[1,1,1,1] row_mask:0xf bank_mask:0xf
    v_add_f32_dpp v14, v46, v14 quad_perm:[2,2,2,2] row_mask:0xf bank_mask:0xf
    v_add_f32_dpp v14, v47, v14 quad_perm:[3,3,3,3] row_mask:0xf bank_mask:0xf
    ds_write_b32 v80, v14 offset:88
    v_mfma_f32_16x16x32_bf16 v[36:39], a[180:183], v[20:23], 0
    v_mfma_f32_16x16x32_bf16 v[36:39], a[184:187], v[24:27], v[36:39]
    v_mfma_f32_16x16x32_bf16 v[36:39], a[188:191], v[28:31], v[36:39]
    v_mov_b32_dpp v14, v32 quad_perm:[0,0,0,0] row_mask:0xf bank_mask:0xf
    v_add_f32_dpp v14, v33, v14 quad_perm:[1,1,1,1] row_mask:0xf bank_mask:0xf
    v_add_f32_dpp v14, v34, v14 quad_perm:[2,2,2,2] row_mask:0xf bank_mask:0xf
    v_add_f32_dpp v14, v35, v14 quad_perm:[3,3,3,3] row_mask:0xf bank_mask:0xf
    ds_write_b32 v80, v14 offset:56
    s_nop 7
    v_mov_b32_dpp v14, v36 quad_perm:[0,0,0,0] row_mask:0xf bank_mask:0xf
    v_add_f32_dpp v14, v37, v14 quad_perm:[1,1,1,1] row_mask:0xf bank_mask:0xf
    v_add_f32_dpp v14, v38, v14 quad_perm:[2,2,2,2] row_mask:0xf bank_mask:0xf
    v_add_f32_dpp v14, v39, v14 quad_perm:[3,3,3,3] row_mask:0xf bank_mask:0xf
    ds_write_b32 v80, v14 offset:60
    v_add_u32 v80, 96, v80
    s_add_u32 s80, s80, s82
    s_add_u32 s76, s76, 1
L_kseq0:
    s_cmp_eq_u32 s42, 0
    s_cbranch_scc0 L_ws1a
    s_movk_i32 s3, 0
    buffer_load_dwordx4 a[0:3], v3, s[28:31], s3 offen offset:0
    buffer_load_dwordx4 a[4:7], v3, s[28:31], s3 offen offset:256
    buffer_load_dwordx4 a[8:11], v3, s[28:31], s3 offen offset:512
    buffer_load_dwordx4 a[12:15], v3, s[28:31], s3 offen offset:768
    buffer_load_dwordx4 a[16:19], v3, s[28:31], s3 offen offset:1024
    s_call_b64 s[58:59], L_kblock
    buffer_load_dword v82, v3, s[32:35], s18 offen
    buffer_load_dword v82, v3, s[32:35], s18 offen
    buffer_load_dword v82, v3, s[32:35], s18 offen
    buffer_load_dword v82, v3, s[32:35], s18 offen
    buffer_load_dword v82, v3, s[32:35], s18 offen
    s_branch L_ws1b
L_ws1a:
    buffer_load_dword v82, v3, s[28:31], s18 offen
    buffer_load_dword v82, v3, s[28:31], s18 offen
    buffer_load_dword v82, v3, s[28:31], s18 offen
    buffer_load_dword v82, v3, s[28:31], s18 offen
    buffer_load_dword v82, v3, s[28:31], s18 offen
    s_call_b64 s[58:59], L_kblock
    s_movk_i32 s3, 0
    buffer_load_dwordx4 a[0:3], v3, s[32:35], s3 offen offset:0
    buffer_load_dwordx4 a[4:7], v3, s[32:35], s3 offen offset:256
    buffer_load_dwordx4 a[8:11], v3, s[32:35], s3 offen offset:512
    buffer_load_dwordx4 a[12:15], v3, s[32:35], s3 offen offset:768
    buffer_load_dwordx4 a[16:19], v3, s[32:35], s3 offen offset:1024
L_ws1b:
    s_call_b64 s[58:59], L_kblock2
    s_cmp_eq_u32 s42, 0
    s_cbranch_scc0 L_ws2a
    s_movk_i32 s3, 0
    buffer_load_dwordx4 a[20:23], v3, s[28:31], s3 offen offset:1280
    buffer_load_dwordx4 a[24:27], v3, s[28:31], s3 offen offset:1536
    buffer_load_dwordx4 a[28:31], v3, s[28:31], s3 offen offset:1792
    buffer_load_dwordx4 a[32:35], v3, s[28:31], s3 offen offset:2048
    buffer_load_dwordx4 a[36:39], v3, s[28:31], s3 offen offset:2304
    s_call_b64 s[58:59], L_kblock
    buffer_load_dword v82, v3, s[32:35], s18 offen
    buffer_load_dword v82, v3, s[32:35], s18 offen
    buffer_load_dword v82, v3, s[32:35], s18 offen
    buffer_load_dword v82, v3, s[32:35], s18 offen
    buffer_load_dword v82, v3, s[32:35], s18 offen
    s_branch L_ws2b
L_ws2a:
    buffer_load_dword v82, v3, s[28:31], s18 offen
    buffer_load_dword v82, v3, s[28:31], s18 offen
    buffer_load_dword v82, v3, s[28:31], s18 offen
    buffer_load_dword v82, v3, s[28:31], s18 offen
    buffer_load_dword v82, v3, s[28:31], s18 offen
    s_call_b64 s[58:59], L_kblock
    s_movk_i32 s3, 0
    buffer_load_dwordx4 a[20:23], v3, s[32:35], s3 offen offset:1280
    buffer_load_dwordx4 a[24:27], v3, s[32:35], s3 offen offset:1536
    buffer_load_dwordx4 a[28:31], v3, s[32:35], s3 offen offset:1792
    buffer_load_dwordx4 a[32:35], v3, s[32:35], s3 offen offset:2048
    buffer_load_dwordx4 a[36:39], v3, s[32:35], s3 offen offset:2304
L_ws2b:
    s_call_b64 s[58:59], L_kblock2
    s_cmp_eq_u32 s42, 0
    s_cbranch_scc0 L_ws3a
    s_movk_i32 s3, 0
    buffer_load_dwordx4 a[40:43], v3, s[28:31], s3 offen offset:2560
    buffer_load_dwordx4 a[44:47], v3, s[28:31], s3 offen offset:2816
    buffer_load_dwordx4 a[48:51], v3, s[28:31], s3 offen offset:3072
    buffer_load_dwordx4 a[52:55], v3, s[28:31], s3 offen offset:3328
    buffer_load_dwordx4 a[56:59], v3, s[28:31], s3 offen offset:3584
    s_call_b64 s[58:59], L_kblock
    buffer_load_dword v82, v3, s[32:35], s18 offen
    buffer_load_dword v82, v3, s[32:35], s18 offen
    buffer_load_dword v82, v3, s[32:35], s18 offen
    buffer_load_dword v82, v3, s[32:35], s18 offen
    buffer_load_dword v82, v3, s[32:35], s18 offen
    s_branch L_ws3b
L_ws3a:
    buffer_load_dword v82, v3, s[28:31], s18 offen
    buffer_load_dword v82, v3, s[28:31], s18 offen
    buffer_load_dword v82, v3, s[28:31], s18 offen
    buffer_load_dword v82, v3, s[28:31], s18 offen
    buffer_load_dword v82, v3, s[28:31], s18 offen
    s_call_b64 s[58:59], L_kblock
    s_movk_i32 s3, 0
    buffer_load_dwordx4 a[40:43], v3, s[32:35], s3 offen offset:2560
    buffer_load_dwordx4 a[44:47], v3, s[32:35], s3 offen offset:2816
    buffer_load_dwordx4 a[48:51], v3, s[32:35], s3 offen offset:3072
    buffer_load_dwordx4 a[52:55], v3, s[32:35], s3 offen offset:3328
    buffer_load_dwordx4 a[56:59], v3, s[32:35], s3 offen offset:3584
L_ws3b:
    s_call_b64 s[58:59], L_kblock2
    s_cmp_eq_u32 s42, 0
    s_cbranch_scc0 L_ws4a
    s_movk_i32 s3, 3840
    buffer_load_dwordx4 a[60:63], v3, s[28:31], s3 offen offset:0
    buffer_load_dwordx4 a[64:67], v3, s[28:31], s3 offen offset:256
    buffer_load_dwordx4 a[68:71], v3, s[28:31], s3 offen offset:512
    buffer_load_dwordx4 a[72:75], v3, s[28:31], s3 offen offset:768
    buffer_load_dwordx4 a[76:79], v3, s[28:31], s3 offen offset:1024
    s_call_b64 s[58:59], L_kblock
    buffer_load_dword v82, v3, s[32:35], s18 offen
    buffer_load_dword v82, v3, s[32:35], s18 offen
    buffer_load_dword v82, v3, s[32:35], s18 offen
    buffer_load_dword v82, v3, s[32:35], s18 offen
    buffer_load_dword v82, v3, s[32:35], s18 offen
    s_branch L_ws4b
L_ws4a:
    buffer_load_dword v82, v3, s[28:31], s18 offen
    buffer_load_dword v82, v3, s[28:31], s18 offen
    buffer_load_dword v82, v3, s[28:31], s18 offen
    buffer_load_dword v82, v3, s[28:31], s18 offen
    buffer_load_dword v82, v3, s[28:31], s18 offen
    s_call_b64 s[58:59], L_kblock
    s_movk_i32 s3, 3840
    buffer_load_dwordx4 a[60:63], v3, s[32:35], s3 offen offset:0
    buffer_load_dwordx4 a[64:67], v3, s[32:35], s3 offen offset:256
    buffer_load_dwordx4 a[68:71], v3, s[32:35], s3 offen offset:512
    buffer_load_dwordx4 a[72:75], v3, s[32:35], s3 offen offset:768
    buffer_load_dwordx4 a[76:79], v3, s[32:35], s3 offen offset:1024
L_ws4b:
    s_call_b64 s[58:59], L_kblock2
    s_cmp_eq_u32 s42, 0
    s_cbranch_scc0 L_ws5a
    s_movk_i32 s3, 3840
    buffer_load_dwordx4 a[80:83], v3, s[28:31], s3 offen offset:1280
    buffer_load_dwordx4 a[84:87], v3, s[28:31], s3 offen offset:1536
    buffer_load_dwordx4 a[88:91], v3, s[28:31], s3 offen offset:1792
    buffer_load_dwordx4 a[92:95], v3, s[28:31], s3 offen offset:2048
    buffer_load_dwordx4 a[96:99], v3, s[28:31], s3 offen offset:2304
    s_call_b64 s[58:59], L_kblock
    buffer_load_dword v82, v3, s[32:35], s18 offen
    buffer_load_dword v82, v3, s[32:35], s18 offen
    buffer_load_dword v82, v3, s[32:35], s18 offen
    buffer_load_dword v82, v3, s[32:35], s18 offen
    buffer_load_dword v82, v3, s[32:35], s18 offen
    s_branch L_ws5b
L_ws5a:
    buffer_load_dword v82, v3, s[28:31], s18 offen
    buffer_load_dword v82, v3, s[28:31], s18 offen
    buffer_load_dword v82, v3, s[28:31], s18 offen
    buffer_load_dword v82, v3, s[28:31], s18 offen
    buffer_load_dword v82, v3, s[28:31], s18 offen
    s_call_b64 s[58:59], L_kblock
    s_movk_i32 s3, 3840
    buffer_load_dwordx4 a[80:83], v3, s[32:35], s3 offen offset:1280
    buffer_load_dwordx4 a[84:87], v3, s[32:35], s3 offen offset:1536
    buffer_load_dwordx4 a[88:91], v3, s[32:35], s3 offen offset:1792
    buffer_load_dwordx4 a[92:95], v3, s[32:35], s3 offen offset:2048
    buffer_load_dwordx4 a[96:99], v3, s[32:35], s3 offen offset:2304
L_ws5b:
    s_call_b64 s[58:59], L_kblock2
    s_cmp_eq_u32 s42, 0
    s_cbranch_scc0 L_ws6a
    s_movk_i32 s3, 3840
    buffer_load_dwordx4 a[100:103], v3, s[28:31], s3 offen offset:2560
    buffer_load_dwordx4 a[104:107], v3, s[28:31], s3 offen offset:2816
    buffer_load_dwordx4 a[108:111], v3, s[28:31], s3 offen offset:3072
    buffer_load_dwordx4 a[112:115], v3, s[28:31], s3 offen offset:3328
    buffer_load_dwordx4 a[116:119], v3, s[28:31], s3 offen offset:3584
    s_call_b64 s[58:59], L_kblock
    buffer_load_dword v82, v3, s[32:35], s18 offen
    buffer_load_dword v82, v3, s[32:35], s18 offen
    buffer_load_dword v82, v3, s[32:35], s18 offen
    buffer_load_dword v82, v3, s[32:35], s18 offen
    buffer_load_dword v82, v3, s[32:35], s18 offen
    s_branch L_ws6b
L_ws6a:
    buffer_load_dword v82, v3, s[28:31], s18 offen
    buffer_load_dword v82, v3, s[28:31], s18 offen
    buffer_load_dword v82, v3, s[28:31], s18 offen
    buffer_load_dword v82, v3, s[28:31], s18 offen
    buffer_load_dword v82, v3, s[28:31], s18 offen
    s_call_b64 s[58:59], L_kblock
    s_movk_i32 s3, 3840
    buffer_load_dwordx4 a[100:103], v3, s[32:35], s3 offen offset:2560
    buffer_load_dwordx4 a[104:107], v3, s[32:35], s3 offen offset:2816
    buffer_load_dwordx4 a[108:111], v3, s[32:35], s3 offen offset:3072
    buffer_load_dwordx4 a[112:115], v3, s[32:35], s3 offen offset:3328
    buffer_load_dwordx4 a[116:119], v3, s[32:35], s3 offen offset:3584
L_ws6b:
    s_call_b64 s[58:59], L_kblock2
    s_cmp_eq_u32 s42, 0
    s_cbranch_scc0 L_ws7a
    s_movk_i32 s3, 7680
    buffer_load_dwordx4 a[120:123], v3, s[28:31], s3 offen offset:0
    buffer_load_dwordx4 a[124:127], v3, s[28:31], s3 offen offset:256
    buffer_load_dwordx4 a[128:131], v3, s[28:31], s3 offen offset:512
    buffer_load_dwordx4 a[132:135], v3, s[28:31], s3 offen offset:768
    buffer_load_dwordx4 a[136:139], v3, s[28:31], s3 offen offset:1024
    s_call_b64 s[58:59], L_kblock
    buffer_load_dword v82, v3, s[32:35], s18 offen
    buffer_load_dword v82, v3, s[32:35], s18 offen
    buffer_load_dword v82, v3, s[32:35], s18 offen
    buffer_load_dword v82, v3, s[32:35], s18 offen
    buffer_load_dword v82, v3, s[32:35], s18 offen
    s_branch L_ws7b
L_ws7a:
    buffer_load_dword v82, v3, s[28:31], s18 offen
    buffer_load_dword v82, v3, s[28:31], s18 offen
    buffer_load_dword v82, v3, s[28:31], s18 offen
    buffer_load_dword v82, v3, s[28:31], s18 offen
    buffer_load_dword v82, v3, s[28:31], s18 offen
    s_call_b64 s[58:59], L_kblock
    s_movk_i32 s3, 7680
    buffer_load_dwordx4 a[120:123], v3, s[32:35], s3 offen offset:0
    buffer_load_dwordx4 a[124:127], v3, s[32:35], s3 offen offset:256
    buffer_load_dwordx4 a[128:131], v3, s[32:35], s3 offen offset:512
    buffer_load_dwordx4 a[132:135], v3, s[32:35], s3 offen offset:768
    buffer_load_dwordx4 a[136:139], v3, s[32:35], s3 offen offset:1024
L_ws7b:
    s_call_b64 s[58:59], L_kblock2
    s_cmp_eq_u32 s42, 0
    s_cbranch_scc0 L_ws8a
    s_movk_i32 s3, 7680
    buffer_load_dwordx4 a[140:143], v3, s[28:31], s3 offen offset:1280
    buffer_load_dwordx4 a[144:147], v3, s[28:31], s3 offen offset:1536
    buffer_load_dwordx4 a[148:151], v3, s[28:31], s3 offen offset:1792
    buffer_load_dwordx4 a[152:155], v3, s[28:31], s3 offen offset:2048
    buffer_load_dwordx4 a[156:159], v3, s[28:31], s3 offen offset:2304
    s_call_b64 s[58:59], L_kblock
    buffer_load_dword v82, v3, s[32:35], s18 offen
    buffer_load_dword v82, v3, s[32:35], s18 offen
    buffer_load_dword v82, v3, s[32:35], s18 offen
    buffer_load_dword v82, v3, s[32:35], s18 offen
    buffer_load_dword v82, v3, s[32:35], s18 offen
    s_branch L_ws8b
L_ws8a:
    buffer_load_dword v82, v3, s[28:31], s18 offen
    buffer_load_dword v82, v3, s[28:31], s18 offen
    buffer_load_dword v82, v3, s[28:31], s18 offen
    buffer_load_dword v82, v3, s[28:31], s18 offen
    buffer_load_dword v82, v3, s[28:31], s18 offen
    s_call_b64 s[58:59], L_kblock
    s_movk_i32 s3, 7680
    buffer_load_dwordx4 a[140:143], v3, s[32:35], s3 offen offset:1280
    buffer_load_dwordx4 a[144:147], v3, s[32:35], s3 offen offset:1536
    buffer_load_dwordx4 a[148:151], v3, s[32:35], s3 offen offset:1792
    buffer_load_dwordx4 a[152:155], v3, s[32:35], s3 offen offset:2048
    buffer_load_dwordx4 a[156:159], v3, s[32:35], s3 offen offset:2304
L_ws8b:
    s_call_b64 s[58:59], L_kblock2
    s_cmp_eq_u32 s42, 0
    s_cbranch_scc0 L_ws9a
    s_movk_i32 s3, 7680
    buffer_load_dwordx4 a[160:163], v3, s[28:31], s3 offen offset:2560
    buffer_load_dwordx4 a[164:167], v3, s[28:31], s3 offen offset:2816
    buffer_load_dwordx4 a[168:171], v3, s[28:31], s3 offen offset:3072
    buffer_load_dwordx4 a[172:175], v3, s[28:31], s3 offen offset:3328
    buffer_load_dwordx4 a[176:179], v3, s[28:31], s3 offen offset:3584
    s_call_b64 s[58:59], L_kblock
    buffer_load_dword v82, v3, s[32:35], s18 offen
    buffer_load_dword v82, v3, s[32:35], s18 offen
    buffer_load_dword v82, v3, s[32:35], s18 offen
    buffer_load_dword v82, v3, s[32:35], s18 offen
    buffer_load_dword v82, v3, s[32:35], s18 offen
    s_branch L_ws9b
L_ws9a:
    buffer_load_dword v82, v3, s[28:31], s18 offen
    buffer_load_dword v82, v3, s[28:31], s18 offen
    buffer_load_dword v82, v3, s[28:31], s18 offen
    buffer_load_dword v82, v3, s[28:31], s18 offen
    buffer_load_dword v82, v3, s[28:31], s18 offen
    s_call_b64 s[58:59], L_kblock
    s_movk_i32 s3, 7680
    buffer_load_dwordx4 a[160:163], v3, s[32:35], s3 offen offset:2560
    buffer_load_dwordx4 a[164:167], v3, s[32:35], s3 offen offset:2816
    buffer_load_dwordx4 a[168:171], v3, s[32:35], s3 offen offset:3072
    buffer_load_dwordx4 a[172:175], v3, s[32:35], s3 offen offset:3328
    buffer_load_dwordx4 a[176:179], v3, s[32:35], s3 offen offset:3584
L_ws9b:
    s_call_b64 s[58:59], L_kblock2
    s_cmp_eq_u32 s42, 0
    s_cbranch_scc0 L_ws10a
    s_movk_i32 s3, 11520
    buffer_load_dwordx4 a[180:183], v3, s[28:31], s3 offen offset:0
    buffer_load_dwordx4 a[184:187], v3, s[28:31], s3 offen offset:256
    buffer_load_dwordx4 a[188:191], v3, s[28:31], s3 offen offset:512
    buffer_load_dwordx4 a[192:195], v3, s[28:31], s3 offen offset:768
    buffer_load_dwordx4 a[196:199], v3, s[28:31], s3 offen offset:1024
    s_call_b64 s[58:59], L_kblock
    buffer_load_dword v82, v3, s[32:35], s18 offen
    buffer_load_dword v82, v3, s[32:35], s18 offen
    buffer_load_dword v82, v3, s[32:35], s18 offen
    buffer_load_dword v82, v3, s[32:35], s18 offen
    buffer_load_dword v82, v3, s[32:35], s18 offen
    s_branch L_ws10b
L_ws10a:
    buffer_load_dword v82, v3, s[28:31], s18 offen
    buffer_load_dword v82, v3, s[28:31], s18 offen
    buffer_load_dword v82, v3, s[28:31], s18 offen
    buffer_load_dword v82, v3, s[28:31], s18 offen
    buffer_load_dword v82, v3, s[28:31], s18 offen
    s_call_b64 s[58:59], L_kblock
    s_movk_i32 s3, 11520
    buffer_load_dwordx4 a[180:183], v3, s[32:35], s3 offen offset:0
    buffer_load_dwordx4 a[184:187], v3, s[32:35], s3 offen offset:256
    buffer_load_dwordx4 a[188:191], v3, s[32:35], s3 offen offset:512
    buffer_load_dwordx4 a[192:195], v3, s[32:35], s3 offen offset:768
    buffer_load_dwordx4 a[196:199], v3, s[32:35], s3 offen offset:1024
L_ws10b:
    s_call_b64 s[58:59], L_kblock2
    s_cmp_eq_u32 s42, 0
    s_cbranch_scc0 L_ws11a
    s_movk_i32 s3, 11520
    buffer_load_dwordx4 a[200:203], v3, s[28:31], s3 offen offset:1280
    buffer_load_dwordx4 a[204:207], v3, s[28:31], s3 offen offset:1536
    buffer_load_dwordx4 a[208:211], v3, s[28:31], s3 offen offset:1792
    buffer_load_dwordx4 a[212:215], v3, s[28:31], s3 offen offset:2048
    buffer_load_dwordx4 a[216:219], v3, s[28:31], s3 offen offset:2304
    s_call_b64 s[58:59], L_kblock
    buffer_load_dword v82, v3, s[32:35], s18 offen
    buffer_load_dword v82, v3, s[32:35], s18 offen
    buffer_load_dword v82, v3, s[32:35], s18 offen
    buffer_load_dword v82, v3, s[32:35], s18 offen
    buffer_load_dword v82, v3, s[32:35], s18 offen
    s_branch L_ws11b
L_ws11a:
    buffer_load_dword v82, v3, s[28:31], s18 offen
    buffer_load_dword v82, v3, s[28:31], s18 offen
    buffer_load_dword v82, v3, s[28:31], s18 offen
    buffer_load_dword v82, v3, s[28:31], s18 offen
    buffer_load_dword v82, v3, s[28:31], s18 offen
    s_call_b64 s[58:59], L_kblock
    s_movk_i32 s3, 11520
    buffer_load_dwordx4 a[200:203], v3, s[32:35], s3 offen offset:1280
    buffer_load_dwordx4 a[204:207], v3, s[32:35], s3 offen offset:1536
    buffer_load_dwordx4 a[208:211], v3, s[32:35], s3 offen offset:1792
    buffer_load_dwordx4 a[212:215], v3, s[32:35], s3 offen offset:2048
    buffer_load_dwordx4 a[216:219], v3, s[32:35], s3 offen offset:2304
L_ws11b:
    s_call_b64 s[58:59], L_kblock2
    s_cmp_eq_u32 s42, 0
    s_cbranch_scc0 L_ws12a
    s_movk_i32 s3, 11520
    buffer_load_dwordx4 a[220:223], v3, s[28:31], s3 offen offset:2560
    buffer_load_dwordx4 a[224:227], v3, s[28:31], s3 offen offset:2816
    buffer_load_dwordx4 a[228:231], v3, s[28:31], s3 offen offset:3072
    buffer_load_dwordx4 a[232:235], v3, s[28:31], s3 offen offset:3328
    buffer_load_dwordx4 a[236:239], v3, s[28:31], s3 offen offset:3584
    s_call_b64 s[58:59], L_kblock
    buffer_load_dword v82, v3, s[32:35], s18 offen
    buffer_load_dword v82, v3, s[32:35], s18 offen
    buffer_load_dword v82, v3, s[32:35], s18 offen
    buffer_load_dword v82, v3, s[32:35], s18 offen
    buffer_load_dword v82, v3, s[32:35], s18 offen
    s_branch L_ws12b
L_ws12a:
    buffer_load_dword v82, v3, s[28:31], s18 offen
    buffer_load_dword v82, v3, s[28:31], s18 offen
    buffer_load_dword v82, v3, s[28:31], s18 offen
    buffer_load_dword v82, v3, s[28:31], s18 offen
    buffer_load_dword v82, v3, s[28:31], s18 offen
    s_call_b64 s[58:59], L_kblock
    s_movk_i32 s3, 11520
    buffer_load_dwordx4 a[220:223], v3, s[32:35], s3 offen offset:2560
    buffer_load_dwordx4 a[224:227], v3, s[32:35], s3 offen offset:2816
    buffer_load_dwordx4 a[228:231], v3, s[32:35], s3 offen offset:3072
    buffer_load_dwordx4 a[232:235], v3, s[32:35], s3 offen offset:3328
    buffer_load_dwordx4 a[236:239], v3, s[32:35], s3 offen offset:3584
L_ws12b:
    s_call_b64 s[58:59], L_kblock2
L_kdone:
    s_mul_i32 s82, s82, 236
    s_lshr_b32 s82, s82, 8
    s_add_u32 s80, s80, s82
    s_add_u32 s76, s76, 1
    s_waitcnt vmcnt(5)
    v_mfma_f32_16x16x32_bf16 v[44:47], v[84:87], v[20:23], 0
    buffer_load_dwordx4 v[84:87], v5, s[16:19], s47 offen offset:0 nt
    s_waitcnt vmcnt(5)
    v_mfma_f32_16x16x32_bf16 v[44:47], v[88:91], v[24:27], v[44:47]
    buffer_load_dwordx4 v[88:91], v5, s[16:19], s47 offen offset:128 nt
    s_waitcnt vmcnt(5)
    v_mfma_f32_16x16x32_bf16 v[44:47], v[92:95], v[28:31], v[44:47]
    buffer_load_dwordx4 v[92:95], v5, s[16:19], s47 offen offset:256 nt
    s_add_u32 s86, s86, 4
    s_cmp_ge_u32 s86, 63
    s_cselect_b32 s3, 63, 0
    s_cselect_b32 s4, 196608, 0
    s_sub_u32 s86, s86, s3
    s_add_u32 s87, s87, s4
    s_cmp_eq_u32 s87, s18
    s_cselect_b32 s87, 0, s87
    s_mul_i32 s3, s86, 49
    s_lshr_b32 s3, s3, 10
    s_mul_i32 s3, s3, 33408
    s_mul_i32 s47, s86, 1536
    s_add_u32 s3, s3, s87
    s_add_u32 s47, s47, s3
    v_add_u32 v80, -4, v80
    v_mov_b32_dpp v14, v48 quad_perm:[0,0,0,0] row_mask:0xf bank_mask:0xf
    v_add_f32_dpp v14, v49, v14 quad_perm:[1,1,1,1] row_mask:0xf bank_mask:0xf
    v_add_f32_dpp v14, v50, v14 quad_perm:[2,2,2,2] row_mask:0xf bank_mask:0xf
    v_add_f32_dpp v14, v51, v14 quad_perm:[3,3,3,3] row_mask:0xf bank_mask:0xf
    ds_write_b32 v80, v14 offset:0
    s_waitcnt vmcnt(5)
    v_mfma_f32_16x16x32_bf16 v[48:51], v[96:99], v[20:23], 0
    buffer_load_dwordx4 v[96:99], v5, s[16:19], s47 offen offset:0 nt
    s_waitcnt vmcnt(5)
    v_mfma_f32_16x16x32_bf16 v[48:51], v[100:103], v[24:27], v[48:51]
    buffer_load_dwordx4 v[100:103], v5, s[16:19], s47 offen offset:128 nt
    s_waitcnt vmcnt(5)
    v_mfma_f32_16x16x32_bf16 v[48:51], v[104:107], v[28:31], v[48:51]
    buffer_load_dwordx4 v[104:107], v5, s[16:19], s47 offen offset:256 nt
    s_add_u32 s86, s86, 4
    s_cmp_ge_u32 s86, 63
    s_cselect_b32 s3, 63, 0
    s_cselect_b32 s4, 196608, 0
    s_sub_u32 s86, s86, s3
    s_add_u32 s87, s87, s4
    s_cmp_eq_u32 s87, s18
    s_cselect_b32 s87, 0, s87
    s_mul_i32 s3, s86, 49
    s_lshr_b32 s3, s3, 10
    s_mul_i32 s3, s3, 33408
    s_mul_i32 s47, s86, 1536
    s_add_u32 s3, s3, s87
    s_add_u32 s47, s47, s3
    v_mov_b32_dpp v14, v44 quad_perm:[0,0,0,0] row_mask:0xf bank_mask:0xf
    v_add_f32_dpp v14, v45, v14 quad_perm:[1,1,1,1] row_mask:0xf bank_mask:0xf
    v_add_f32_dpp v14, v46, v14 quad_perm:[2,2,2,2] row_mask:0xf bank_mask:0xf
    v_add_f32_dpp v14, v47, v14 quad_perm:[3,3,3,3] row_mask:0xf bank_mask:0xf
    ds_write_b32 v80, v14 offset:4
    s_waitcnt vmcnt(5)
    v_mfma_f32_16x16x32_bf16 v[44:47], v[108:111], v[20:23], 0
    buffer_load_dwordx4 v[108:111], v76, s[16:19], s94 offen offset:0 nt
    s_waitcnt vmcnt(5)
    v_mfma_f32_16x16x32_bf16 v[44:47], v[112:115], v[24:27], v[44:47]
    buffer_load_dwordx4 v[112:115], v76, s[16:19], s94 offen offset:128 nt
    s_waitcnt vmcnt(5)
    v_mfma_f32_16x16x32_bf16 v[44:47], v[116:119], v[28:31], v[44:47]
    buffer_load_dwordx4 v[116:119], v76, s[16:19], s94 offen offset:256 nt
    s_xor_b32 s94, s94, s95
    v_mov_b32_dpp v14, v48 quad_perm:[0,0,0,0] row_mask:0xf bank_mask:0xf
    v_add_f32_dpp v14, v49, v14 quad_perm:[1,1,1,1] row_mask:0xf bank_mask:0xf
    v_add_f32_dpp v14, v50, v14 quad_perm:[2,2,2,2] row_mask:0xf bank_mask:0xf
    v_add_f32_dpp v14, v51, v14 quad_perm:[3,3,3,3] row_mask:0xf bank_mask:0xf
    ds_write_b32 v80, v14 offset:8
    s_waitcnt vmcnt(5)
    v_mfma_f32_16x16x32_bf16 v[48:51], v[120:123], v[20:23], 0
    buffer_load_dwordx4 v[120:123], v76, s[16:19], s94 offen offset:0 nt
    s_waitcnt vmcnt(5)
    v_mfma_f32_16x16x32_bf16 v[48:51], v[124:127], v[24:27], v[48:51]
    buffer_load_dwordx4 v[124:127], v76, s[16:19], s94 offen offset:128 nt
    s_waitcnt vmcnt(5)
    v_mfma_f32_16x16x32_bf16 v[48:51], v[128:131], v[28:31], v[48:51]
    buffer_load_dwordx4 v[128:131], v76, s[16:19], s94 offen offset:256 nt
    s_xor_b32 s94, s94, s95
    v_mov_b32_dpp v14, v44 quad_perm:[0,0,0,0] row_mask:0xf bank_mask:0xf
    v_add_f32_dpp v14, v45, v14 quad_perm:[1,1,1,1] row_mask:0xf bank_mask:0xf
    v_add_f32_dpp v14, v46, v14 quad_perm:[2,2,2,2] row_mask:0xf bank_mask:0xf
    v_add_f32_dpp v14, v47, v14 quad_perm:[3,3,3,3] row_mask:0xf bank_mask:0xf
    ds_write_b32 v80, v14 offset:12
    s_waitcnt vmcnt(5)
    v_mfma_f32_16x16x32_bf16 v[44:47], v[84:87], v[20:23], 0
    buffer_load_dwordx4 v[84:87], v6, s[20:23], s47 offen offset:0 nt
    s_waitcnt vmcnt(5)
    v_mfma_f32_16x16x32_bf16 v[44:47], v[88:91], v[24:27], v[44:47]
    buffer_load_dwordx4 v[88:91], v6, s[20:23], s47 offen offset:128 nt
    s_waitcnt vmcnt(5)
    v_mfma_f32_16x16x32_bf16 v[44:47], v[92:95], v[28:31], v[44:47]
    buffer_load_dwordx4 v[92:95], v6, s[20:23], s47 offen offset:256 nt
    s_add_u32 s86, s86, 4
    s_cmp_ge_u32 s86, 63
    s_cselect_b32 s3, 63, 0
    s_cselect_b32 s4, 196608, 0
    s_sub_u32 s86, s86, s3
    s_add_u32 s87, s87, s4
    s_cmp_eq_u32 s87, s18
    s_cselect_b32 s87, 0, s87
    s_mul_i32 s3, s86, 49
    s_lshr_b32 s3, s3, 10
    s_mul_i32 s3, s3, 33408
    s_mul_i32 s47, s86, 1536
    s_add_u32 s3, s3, s87
    s_add_u32 s47, s47, s3
    v_mov_b32_dpp v14, v48 quad_perm:[0,0,0,0] row_mask:0xf bank_mask:0xf
    v_add_f32_dpp v14, v49, v14 quad_perm:[1,1,1,1] row_mask:0xf bank_mask:0xf
    v_add_f32_dpp v14, v50, v14 quad_perm:[2,2,2,2] row_mask:0xf bank_mask:0xf
    v_add_f32_dpp v14, v51, v14 quad_perm:[3,3,3,3] row_mask:0xf bank_mask:0xf
    ds_write_b32 v80, v14 offset:16
    s_waitcnt vmcnt(5)
    v_mfma_f32_16x16x32_bf16 v[48:51], v[96:99], v[20:23], 0
    buffer_load_dwordx4 v[96:99], v6, s[20:23], s47 offen offset:0 nt
    s_waitcnt vmcnt(5)
    v_mfma_f32_16x16x32_bf16 v[48:51], v[100:103], v[24:27], v[48:51]
    buffer_load_dwordx4 v[100:103], v6, s[20:23], s47 offen offset:128 nt
    s_waitcnt vmcnt(5)
    v_mfma_f32_16x16x32_bf16 v[48:51], v[104:107], v[28:31], v[48:51]
    buffer_load_dwordx4 v[104:107], v6, s[20:23], s47 offen offset:256 nt
    s_add_u32 s86, s86, 4
    s_cmp_ge_u32 s86, 63
    s_cselect_b32 s3, 63, 0
    s_cselect_b32 s4, 196608, 0
    s_sub_u32 s86, s86, s3
    s_add_u32 s87, s87, s4
    s_cmp_eq_u32 s87, s18
    s_cselect_b32 s87, 0, s87
    s_mul_i32 s3, s86, 49
    s_lshr_b32 s3, s3, 10
    s_mul_i32 s3, s3, 33408
    s_mul_i32 s47, s86, 1536
    s_add_u32 s3, s3, s87
    s_add_u32 s47, s47, s3
    v_mov_b32_dpp v14, v44 quad_perm:[0,0,0,0] row_mask:0xf bank_mask:0xf
    v_add_f32_dpp v14, v45, v14 quad_perm:[1,1,1,1] row_mask:0xf bank_mask:0xf
    v_add_f32_dpp v14, v46, v14 quad_perm:[2,2,2,2] row_mask:0xf bank_mask:0xf
    v_add_f32_dpp v14, v47, v14 quad_perm:[3,3,3,3] row_mask:0xf bank_mask:0xf
    ds_write_b32 v80, v14 offset:20
    s_waitcnt vmcnt(5)
    v_mfma_f32_16x16x32_bf16 v[44:47], v[108:111], v[20:23], 0
    buffer_load_dwordx4 v[108:111], v6, s[20:23], s47 offen offset:0 nt
    s_waitcnt vmcnt(5)
    v_mfma_f32_16x16x32_bf16 v[44:47], v[112:115], v[24:27], v[44:47]
    buffer_load_dwordx4 v[112:115], v6, s[20:23], s47 offen offset:128 nt
    s_waitcnt vmcnt(5)
    v_mfma_f32_16x16x32_bf16 v[44:47], v[116:119], v[28:31], v[44:47]
    buffer_load_dwordx4 v[116:119], v6, s[20:23], s47 offen offset:256 nt
    s_add_u32 s86, s86, 4
    s_cmp_ge_u32 s86, 63
    s_cselect_b32 s3, 63, 0
    s_cselect_b32 s4, 196608, 0
    s_sub_u32 s86, s86, s3
    s_add_u32 s87, s87, s4
    s_cmp_eq_u32 s87, s18
    s_cselect_b32 s87, 0, s87
    s_mul_i32 s3, s86, 49
    s_lshr_b32 s3, s3, 10
    s_mul_i32 s3, s3, 33408
    s_mul_i32 s47, s86, 1536
    s_add_u32 s3, s3, s87
    s_add_u32 s47, s47, s3
    v_mov_b32_dpp v14, v48 quad_perm:[0,0,0,0] row_mask:0xf bank_mask:0xf
    v_add_f32_dpp v14, v49, v14 quad_perm:[1,1,1,1] row_mask:0xf bank_mask:0xf
    v_add_f32_dpp v14, v50, v14 quad_perm:[2,2,2,2] row_mask:0xf bank_mask:0xf
    v_add_f32_dpp v14, v51, v14 quad_perm:[3,3,3,3] row_mask:0xf bank_mask:0xf
    ds_write_b32 v80, v14 offset:24
    s_waitcnt vmcnt(5)
    v_mfma_f32_16x16x32_bf16 v[48:51], v[120:123], v[20:23], 0
    buffer_load_dwordx4 v[120:123], v6, s[20:23], s47 offen offset:0 nt
    s_waitcnt vmcnt(5)
    v_mfma_f32_16x16x32_bf16 v[48:51], v[124:127], v[24:27], v[48:51]
    buffer_load_dwordx4 v[124:127], v6, s[20:23], s47 offen offset:128 nt
    s_waitcnt vmcnt(5)
    v_mfma_f32_16x16x32_bf16 v[48:51], v[128:131], v[28:31], v[48:51]
    buffer_load_dwordx4 v[128:131], v6, s[20:23], s47 offen offset:256 nt
    s_add_u32 s86, s86, 4
    s_cmp_ge_u32 s86, 63
    s_cselect_b32 s3, 63, 0
    s_cselect_b32 s4, 196608, 0
    s_sub_u32 s86, s86, s3
    s_add_u32 s87, s87, s4
    s_cmp_eq_u32 s87, s18
    s_cselect_b32 s87, 0, s87
    s_mul_i32 s3, s86, 49
    s_lshr_b32 s3, s3, 10
    s_mul_i32 s3, s3, 33408
    s_mul_i32 s47, s86, 1536
    s_add_u32 s3, s3, s87
    s_add_u32 s47, s47, s3
    v_mov_b32_dpp v14, v44 quad_perm:[0,0,0,0] row_mask:0xf bank_mask:0xf
    v_add_f32_dpp v14, v45, v14 quad_perm:[1,1,1,1] row_mask:0xf bank_mask:0xf
    v_add_f32_dpp v14, v46, v14 quad_perm:[2,2,2,2] row_mask:0xf bank_mask:0xf
    v_add_f32_dpp v14, v47, v14 quad_perm:[3,3,3,3] row_mask:0xf bank_mask:0xf
    ds_write_b32 v80, v14 offset:28
    s_nop 4
    v_mov_b32_dpp v14, v48 quad_perm:[0,0,0,0] row_mask:0xf bank_mask:0xf
    v_add_f32_dpp v14, v49, v14 quad_perm:[1,1,1,1] row_mask:0xf bank_mask:0xf
    v_add_f32_dpp v14, v50, v14 quad_perm:[2,2,2,2] row_mask:0xf bank_mask:0xf
    v_add_f32_dpp v14, v51, v14 quad_perm:[3,3,3,3] row_mask:0xf bank_mask:0xf
    ds_write_b32 v80, v14 offset:32
    v_lshrrev_b32 v10, 3, v1
    v_mul_u32_u24 v8, 528, v10
    v_and_b32 v9, 7, v1
    v_lshl_add_u32 v8, v9, 6, v8
    v_mul_u32_u24 v14, 4224, v7
    v_add_u32 v8, v8, v14
    ds_read_b128 v[132:135], v8 offset:40960
    ds_read_b128 v[136:139], v8 offset:40976
    ds_read_b128 v[140:143], v8 offset:40992
    ds_read_b128 v[144:147], v8 offset:41008
    v_mov_b32 v32, 0
    v_mov_b32 v33, 0
    v_mov_b32 v34, 0
    v_mov_b32 v35, 0
    v_mov_b32 v36, 0
    v_mov_b32 v37, 0
    v_mov_b32 v38, 0
    v_mov_b32 v39, 0
    v_mov_b32 v40, 0
    v_mov_b32 v41, 0
    v_mov_b32 v42, 0
    v_mov_b32 v43, 0
    s_waitcnt lgkmcnt(0)
    v_max3_f32 v11, v132, v133, v134
    v_max3_f32 v11, v135, v136, v11
    v_max3_f32 v11, v137, v138, v11
    v_max3_f32 v11, v139, v140, v11
    v_max3_f32 v11, v141, v142, v11
    v_max3_f32 v11, v143, v144, v11
    v_max3_f32 v11, v145, v146, v11
    v_max_f32 v11, v147, v11
    s_nop 1
    v_max_f32_dpp v11, v11, v11 quad_perm:[1,0,3,2] row_mask:0xf bank_mask:0xf
    s_nop 1
    v_max_f32_dpp v11, v11, v11 quad_perm:[2,3,0,1] row_mask:0xf bank_mask:0xf
    s_nop 1
    v_max_f32_dpp v11, v11, v11 row_ror:4 row_mask:0xf bank_mask:0xf
    s_nop 1
    v_max_f32_dpp v11, v11, v11 row_ror:8 row_mask:0xf bank_mask:0xf
    v_mov_b32 v14, v11
    s_nop 1
    v_permlane16_swap_b32 v11, v14
    v_max_f32 v11, v11, v14
    v_mov_b32 v14, v11
    s_nop 1
    v_permlane32_swap_b32 v11, v14
    v_max_f32 v11, v11, v14
    v_mul_f32 v12, s50, v11
    v_fma_f32 v132, v132, s50, -v12
    v_fma_f32 v133, v133, s50, -v12
    v_fma_f32 v134, v134, s50, -v12
    v_fma_f32 v135, v135, s50, -v12
    v_fma_f32 v136, v136, s50, -v12
    v_fma_f32 v137, v137, s50, -v12
    v_fma_f32 v138, v138, s50, -v12
    v_fma_f32 v139, v139, s50, -v12
    v_fma_f32 v140, v140, s50, -v12
    v_fma_f32 v141, v141, s50, -v12
    v_fma_f32 v142, v142, s50, -v12
    v_fma_f32 v143, v143, s50, -v12
    v_fma_f32 v144, v144, s50, -v12
    v_fma_f32 v145, v145, s50, -v12
    v_fma_f32 v146, v146, s50, -v12
    v_fma_f32 v147, v147, s50, -v12
    v_exp_f32 v132, v132
    v_exp_f32 v133, v133
    v_exp_f32 v134, v134
    v_exp_f32 v135, v135
    v_exp_f32 v136, v136
    v_exp_f32 v137, v137
    v_exp_f32 v138, v138
    v_exp_f32 v139, v139
    v_exp_f32 v140, v140
    v_exp_f32 v141, v141
    v_exp_f32 v142, v142
    v_exp_f32 v143, v143
    v_exp_f32 v144, v144
    v_exp_f32 v145, v145
    v_exp_f32 v146, v146
    v_exp_f32 v147, v147
    v_add_f32 v13, v132, v133
    v_add_f32 v13, v13, v134
    v_add_f32 v13, v13, v135
    v_add_f32 v13, v13, v136
    v_add_f32 v13, v13, v137
    v_add_f32 v13, v13, v138
    v_add_f32 v13, v13, v139
    v_add_f32 v13, v13, v140
    v_add_f32 v13, v13, v141
    v_add_f32 v13, v13, v142
    v_add_f32 v13, v13, v143
    v_add_f32 v13, v13, v144
    v_add_f32 v13, v13, v145
    v_add_f32 v13, v13, v146
    v_add_f32 v13, v13, v147
    v_cvt_pk_bf16_f32 v132, v132, v132
    v_cvt_pk_bf16_f32 v133, v133, v133
    v_cvt_pk_bf16_f32 v134, v134, v134
    v_cvt_pk_bf16_f32 v135, v135, v135
    v_cvt_pk_bf16_f32 v136, v136, v136
    v_cvt_pk_bf16_f32 v137, v137, v137
    v_cvt_pk_bf16_f32 v138, v138, v138
    v_cvt_pk_bf16_f32 v139, v139, v139
    v_cvt_pk_bf16_f32 v140, v140, v140
    v_cvt_pk_bf16_f32 v141, v141, v141
    v_cvt_pk_bf16_f32 v142, v142, v142
    v_cvt_pk_bf16_f32 v143, v143, v143
    v_cvt_pk_bf16_f32 v144, v144, v144
    v_cvt_pk_bf16_f32 v145, v145, v145
    v_cvt_pk_bf16_f32 v146, v146, v146
    v_cvt_pk_bf16_f32 v147, v147, v147
    ds_write_b128 v8, v[132:135] offset:40960
    ds_write_b128 v8, v[136:139] offset:40976
    ds_write_b128 v8, v[140:143] offset:40992
    ds_write_b128 v8, v[144:147] offset:41008
    ds_read_b128 v[60:63], v81
    ds_read_b128 v[64:67], v81 offset:16
    s_nop 1
    v_add_f32_dpp v13, v13, v13 quad_perm:[1,0,3,2] row_mask:0xf bank_mask:0xf
    s_nop 1
    v_add_f32_dpp v13, v13, v13 quad_perm:[2,3,0,1] row_mask:0xf bank_mask:0xf
    s_nop 1
    v_add_f32_dpp v13, v13, v13 row_ror:4 row_mask:0xf bank_mask:0xf
    s_nop 1
    v_add_f32_dpp v13, v13, v13 row_ror:8 row_mask:0xf bank_mask:0xf
    v_mov_b32 v14, v13
    s_nop 1
    v_permlane16_swap_b32 v13, v14
    v_add_f32 v13, v13, v14
    v_mov_b32 v14, v13
    s_nop 1
    v_permlane32_swap_b32 v13, v14
    v_add_f32 v13, v13, v14
    v_mov_b32 v14, v12
    v_mov_b32 v15, v13
    v_lshlrev_b32 v8, 3, v7
    ds_write_b64 v8, v[14:15] offset:8192
    s_waitcnt lgkmcnt(0)
    v_and_b32 v52, v60, v16
    v_and_b32 v53, v60, v17
    v_and_b32 v54, v60, v18
    v_and_b32 v55, v60, v19
    s_call_b64 s[58:59], L_vblock
    v_mov_b32 v8, 0
    ds_read_b128 v[132:135], v8 offset:8192
    ds_read_b128 v[136:139], v8 offset:8208
    ds_read_b32 v11, v8 offset:8244
    s_mov_b32 s45, 14
    s_waitcnt lgkmcnt(0)
    v_readfirstlane_b32 s3, v11
    s_bfe_u32 s24, s3, 0x80000
    s_bfe_u32 s25, s3, 0x80008
    s_bfe_u32 s26, s3, 0x80010
    s_bfe_u32 s27, s3, 0x80018
    v_max_f32 v14, v132, v134
    v_max3_f32 v14, v136, v138, v14
    v_sub_f32 v132, v132, v14
    v_sub_f32 v134, v134, v14
    v_sub_f32 v136, v136, v14
    v_sub_f32 v138, v138, v14
    v_sub_f32 v75, v12, v14
    v_exp_f32 v132, v132
    v_exp_f32 v134, v134
    v_exp_f32 v136, v136
    v_exp_f32 v138, v138
    v_exp_f32 v75, v75
    v_mul_f32 v13, v132, v133
    v_fma_f32 v13, v134, v135, v13
    v_fma_f32 v13, v136, v137, v13
    v_fma_f32 v13, v138, v139, v13
    v_rcp_f32 v13, v13
    s_nop 0
    v_mul_f32 v75, v75, v13
L_vloop:
    s_call_b64 s[58:59], L_vblock
    s_sub_u32 s45, s45, 1
    s_cmp_lg_u32 s45, 0
    s_cbranch_scc1 L_vloop
    v_mul_u32_u24 v8, 192, v7
    v_lshl_add_u32 v8, v1, 4, v8
    v_lshlrev_b32 v9, 3, v1
    v_lshl_add_u32 v9, v7, 9, v9
    v_lshrrev_b32 v10, 4, v1
    v_mul_u32_u24 v10, 24, v10
    v_lshl_add_u32 v10, v7, 9, v10
    v_mov_b32 v28, 0
    v_mov_b32 v29, 0
    v_mov_b32 v30, 0
    v_mov_b32 v31, 0
    s_mov_b32 exec_lo, 0x00ff00ff
    s_mov_b32 exec_hi, 0x00ff00ff
    v_mov_b32 v28, v16
    v_mov_b32 v29, v17
    v_mov_b32 v30, v18
    v_mov_b32 v31, v19
    s_mov_b64 exec, -1
    v_mul_u32_u24 v5, 640, v7
    v_lshlrev_b32 v2, 4, v1
    v_add_u32 v5, v5, v2
    s_mov_b64 s[88:89], s[40:41]
    s_movk_i32 s90, 20480
    s_mov_b32 s91, 0x20000
    s_waitcnt vmcnt(11)
    v_mfma_f32_16x16x32_bf16 v[32:35], v[52:55], v[84:87], v[32:35]
    buffer_load_dwordx4 v[84:87], v6, s[20:23], s47 offen offset:0 nt
    s_waitcnt vmcnt(11)
    v_mfma_f32_16x16x32_bf16 v[36:39], v[52:55], v[88:91], v[36:39]
    buffer_load_dwordx4 v[88:91], v6, s[20:23], s47 offen offset:128 nt
    s_waitcnt vmcnt(11)
    v_mfma_f32_16x16x32_bf16 v[40:43], v[52:55], v[92:95], v[40:43]
    buffer_load_dwordx4 v[92:95], v6, s[20:23], s47 offen offset:256 nt
    s_add_u32 s86, s86, 4
    s_cmp_ge_u32 s86, 63
    s_cselect_b32 s3, 63, 0
    s_cselect_b32 s4, 196608, 0
    s_sub_u32 s86, s86, s3
    s_add_u32 s87, s87, s4
    s_cmp_eq_u32 s87, s18
    s_cselect_b32 s87, 0, s87
    s_mul_i32 s3, s86, 49
    s_lshr_b32 s3, s3, 10
    s_mul_i32 s3, s3, 33408
    s_mul_i32 s47, s86, 1536
    s_add_u32 s3, s3, s87
    s_add_u32 s47, s47, s3
    v_and_b32 v56, v61, v16
    v_and_b32 v57, v61, v17
    v_and_b32 v58, v61, v18
    v_and_b32 v59, v61, v19
    s_nop 0
    s_waitcnt vmcnt(11)
    v_mfma_f32_16x16x32_bf16 v[32:35], v[56:59], v[96:99], v[32:35]
    buffer_load_dwordx4 v[96:99], v6, s[20:23], s47 offen offset:0 nt
    s_waitcnt vmcnt(11)
    v_mfma_f32_16x16x32_bf16 v[36:39], v[56:59], v[100:103], v[36:39]
    buffer_load_dwordx4 v[100:103], v6, s[20:23], s47 offen offset:128 nt
    s_waitcnt vmcnt(11)
    v_mfma_f32_16x16x32_bf16 v[40:43], v[56:59], v[104:107], v[40:43]
    buffer_load_dwordx4 v[104:107], v6, s[20:23], s47 offen offset:256 nt
    s_add_u32 s86, s86, 4
    s_cmp_ge_u32 s86, 63
    s_cselect_b32 s3, 63, 0
    s_cselect_b32 s4, 196608, 0
    s_sub_u32 s86, s86, s3
    s_add_u32 s87, s87, s4
    s_cmp_eq_u32 s87, s18
    s_cselect_b32 s87, 0, s87
    s_mul_i32 s3, s86, 49
    s_lshr_b32 s3, s3, 10
    s_mul_i32 s3, s3, 33408
    s_mul_i32 s47, s86, 1536
    s_add_u32 s3, s3, s87
    s_add_u32 s47, s47, s3
    v_and_b32 v52, v62, v16
    v_and_b32 v53, v62, v17
    v_and_b32 v54, v62, v18
    v_and_b32 v55, v62, v19
    s_nop 0
    s_waitcnt vmcnt(11)
    v_mfma_f32_16x16x32_bf16 v[32:35], v[52:55], v[108:111], v[32:35]
    buffer_load_dwordx4 v[108:111], v77, s[20:23], s94 offen offset:0 nt
    s_waitcnt vmcnt(11)
    v_mfma_f32_16x16x32_bf16 v[36:39], v[52:55], v[112:115], v[36:39]
    buffer_load_dwordx4 v[112:115], v77, s[20:23], s94 offen offset:128 nt
    s_waitcnt vmcnt(11)
    v_mfma_f32_16x16x32_bf16 v[40:43], v[52:55], v[116:119], v[40:43]
    buffer_load_dwordx4 v[116:119], v77, s[20:23], s94 offen offset:256 nt
    s_xor_b32 s94, s94, s95
    v_and_b32 v56, v63, v16
    v_and_b32 v57, v63, v17
    v_and_b32 v58, v63, v18
    v_and_b32 v59, v63, v19
    s_nop 0
    s_waitcnt vmcnt(11)
    v_mfma_f32_16x16x32_bf16 v[32:35], v[56:59], v[120:123], v[32:35]
    buffer_load_dwordx4 v[120:123], v77, s[20:23], s94 offen offset:0 nt
    s_waitcnt vmcnt(11)
    v_mfma_f32_16x16x32_bf16 v[36:39], v[56:59], v[124:127], v[36:39]
    buffer_load_dwordx4 v[124:127], v77, s[20:23], s94 offen offset:128 nt
    s_waitcnt vmcnt(11)
    v_mfma_f32_16x16x32_bf16 v[40:43], v[56:59], v[128:131], v[40:43]
    buffer_load_dwordx4 v[128:131], v77, s[20:23], s94 offen offset:256 nt
    s_xor_b32 s94, s94, s95
    s_waitcnt lgkmcnt(0)
    v_and_b32 v52, v64, v16
    v_and_b32 v53, v64, v17
    v_and_b32 v54, v64, v18
    v_and_b32 v55, v64, v19
    s_nop 0
    s_waitcnt vmcnt(11)
    v_mfma_f32_16x16x32_bf16 v[32:35], v[52:55], v[84:87], v[32:35]
    s_waitcnt vmcnt(10)
    v_mfma_f32_16x16x32_bf16 v[36:39], v[52:55], v[88:91], v[36:39]
    s_waitcnt vmcnt(9)
    v_mfma_f32_16x16x32_bf16 v[40:43], v[52:55], v[92:95], v[40:43]
    v_and_b32 v56, v65, v16
    v_and_b32 v57, v65, v17
    v_and_b32 v58, v65, v18
    v_and_b32 v59, v65, v19
    s_nop 0
    s_waitcnt vmcnt(8)
    v_mfma_f32_16x16x32_bf16 v[32:35], v[56:59], v[96:99], v[32:35]
    s_waitcnt vmcnt(7)
    v_mfma_f32_16x16x32_bf16 v[36:39], v[56:59], v[100:103], v[36:39]
    s_waitcnt vmcnt(6)
    v_mfma_f32_16x16x32_bf16 v[40:43], v[56:59], v[104:107], v[40:43]
    v_and_b32 v52, v66, v16
    v_and_b32 v53, v66, v17
    v_and_b32 v54, v66, v18
    v_and_b32 v55, v66, v19
    s_nop 0
    s_waitcnt vmcnt(5)
    v_mfma_f32_16x16x32_bf16 v[32:35], v[52:55], v[108:111], v[32:35]
    s_waitcnt vmcnt(4)
    v_mfma_f32_16x16x32_bf16 v[36:39], v[52:55], v[112:115], v[36:39]
    s_waitcnt vmcnt(3)
    v_mfma_f32_16x16x32_bf16 v[40:43], v[52:55], v[116:119], v[40:43]
    v_and_b32 v56, v67, v16
    v_and_b32 v57, v67, v17
    v_and_b32 v58, v67, v18
    v_and_b32 v59, v67, v19
    s_nop 0
    s_waitcnt vmcnt(2)
    v_mfma_f32_16x16x32_bf16 v[32:35], v[56:59], v[120:123], v[32:35]
    s_waitcnt vmcnt(1)
    v_mfma_f32_16x16x32_bf16 v[36:39], v[56:59], v[124:127], v[36:39]
    s_waitcnt vmcnt(0)
    v_mfma_f32_16x16x32_bf16 v[40:43], v[56:59], v[128:131], v[40:43]
    s_cmp_lg_u32 s13, 0
    s_cbranch_scc1 L_notick
    v_mov_b32 v11, 0
    v_mov_b32 v13, 1
    s_mov_b64 exec, 1
    global_atomic_add v82, v11, v13, s[38:39] sc0
L_notick:
    s_mov_b32 exec_lo, 0x00ff00ff
    s_mov_b32 exec_hi, 0xff00ff00
    s_nop 4
    v_mul_f32 v32, v32, v75
    v_mul_f32 v33, v33, v75
    v_mul_f32 v34, v34, v75
    v_mul_f32 v35, v35, v75
    v_mul_f32 v36, v36, v75
    v_mul_f32 v37, v37, v75
    v_mul_f32 v38, v38, v75
    v_mul_f32 v39, v39, v75
    v_mul_f32 v40, v40, v75
    v_mul_f32 v41, v41, v75
    v_mul_f32 v42, v42, v75
    v_mul_f32 v43, v43, v75
    ds_write_b128 v78, v[32:35] offset:32768
    ds_write_b128 v78, v[36:39] offset:33024
    ds_write_b128 v78, v[40:43] offset:33280
    s_mov_b64 exec, -1
    s_waitcnt lgkmcnt(0)
    s_barrier
    ds_read_b128 v[84:87], v8 offset:32768
    ds_read_b128 v[88:91], v8 offset:33536
    ds_read_b128 v[92:95], v8 offset:34304
    ds_read_b128 v[96:99], v8 offset:35072
    ds_read_b128 v[100:103], v8 offset:35840
    ds_read_b128 v[104:107], v8 offset:36608
    ds_read_b128 v[108:111], v8 offset:37376
    ds_read_b128 v[112:115], v8 offset:38144
    s_waitcnt lgkmcnt(6)
    v_pk_add_f32 v[84:85], v[84:85], v[88:89]
    v_pk_add_f32 v[86:87], v[86:87], v[90:91]
    s_waitcnt lgkmcnt(5)
    v_pk_add_f32 v[84:85], v[84:85], v[92:93]
    v_pk_add_f32 v[86:87], v[86:87], v[94:95]
    s_waitcnt lgkmcnt(4)
    v_pk_add_f32 v[84:85], v[84:85], v[96:97]
    v_pk_add_f32 v[86:87], v[86:87], v[98:99]
    s_waitcnt lgkmcnt(3)
    v_pk_add_f32 v[84:85], v[84:85], v[100:101]
    v_pk_add_f32 v[86:87], v[86:87], v[102:103]
    s_waitcnt lgkmcnt(2)
    v_pk_add_f32 v[84:85], v[84:85], v[104:105]
    v_pk_add_f32 v[86:87], v[86:87], v[106:107]
    s_waitcnt lgkmcnt(1)
    v_pk_add_f32 v[84:85], v[84:85], v[108:109]
    v_pk_add_f32 v[86:87], v[86:87], v[110:111]
    s_waitcnt lgkmcnt(0)
    v_pk_add_f32 v[84:85], v[84:85], v[112:113]
    v_pk_add_f32 v[86:87], v[86:87], v[114:115]
    v_cvt_pk_bf16_f32 v88, v84, v85
    v_cvt_pk_bf16_f32 v89, v86, v87
    ds_write_b64 v9, v[88:89] offset:6144
    ds_read_b64 v[20:21], v10 offset:6144
    ds_read_b64 v[22:23], v10 offset:6152
    ds_read_b64 v[24:25], v10 offset:6160
    s_waitcnt lgkmcnt(0)
    v_perm_b32 v15, v20, v20, s56
    v_and_b32 v52, v15, v28
    v_and_b32 v53, v15, v29
    v_and_b32 v54, v15, v30
    v_and_b32 v55, v15, v31
    s_nop 1
    v_mfma_f32_16x16x32_bf16 v[84:87], v[52:55], a[0:3], 0
    v_perm_b32 v15, v20, v20, s57
    v_and_b32 v56, v15, v28
    v_and_b32 v57, v15, v29
    v_and_b32 v58, v15, v30
    v_and_b32 v59, v15, v31
    v_mfma_f32_16x16x32_bf16 v[88:91], v[52:55], a[4:7], 0
    v_mfma_f32_16x16x32_bf16 v[92:95], v[52:55], a[8:11], 0
    v_mfma_f32_16x16x32_bf16 v[96:99], v[52:55], a[12:15], 0
    v_mfma_f32_16x16x32_bf16 v[100:103], v[52:55], a[16:19], 0
    v_mfma_f32_16x16x32_bf16 v[84:87], v[56:59], a[20:23], v[84:87]
    v_perm_b32 v15, v21, v21, s56
    v_and_b32 v52, v15, v28
    v_and_b32 v53, v15, v29
    v_and_b32 v54, v15, v30
    v_and_b32 v55, v15, v31
    v_mfma_f32_16x16x32_bf16 v[88:91], v[56:59], a[24:27], v[88:91]
    v_mfma_f32_16x16x32_bf16 v[92:95], v[56:59], a[28:31], v[92:95]
    v_mfma_f32_16x16x32_bf16 v[96:99], v[56:59], a[32:35], v[96:99]
    v_mfma_f32_16x16x32_bf16 v[100:103], v[56:59], a[36:39], v[100:103]
    v_mfma_f32_16x16x32_bf16 v[84:87], v[52:55], a[40:43], v[84:87]
    v_perm_b32 v15, v21, v21, s57
    v_and_b32 v56, v15, v28
    v_and_b32 v57, v15, v29
    v_and_b32 v58, v15, v30
    v_and_b32 v59, v15, v31
    v_mfma_f32_16x16x32_bf16 v[88:91], v[52:55], a[44:47], v[88:91]
    v_mfma_f32_16x16x32_bf16 v[92:95], v[52:55], a[48:51], v[92:95]
    v_mfma_f32_16x16x32_bf16 v[96:99], v[52:55], a[52:55], v[96:99]
    v_mfma_f32_16x16x32_bf16 v[100:103], v[52:55], a[56:59], v[100:103]
    v_mfma_f32_16x16x32_bf16 v[84:87], v[56:59], a[60:63], v[84:87]
    v_perm_b32 v15, v22, v22, s56
    v_and_b32 v52, v15, v28
    v_and_b32 v53, v15, v29
    v_and_b32 v54, v15, v30
    v_and_b32 v55, v15, v31
    v_mfma_f32_16x16x32_bf16 v[88:91], v[56:59], a[64:67], v[88:91]
    v_mfma_f32_16x16x32_bf16 v[92:95], v[56:59], a[68:71], v[92:95]
    v_mfma_f32_16x16x32_bf16 v[96:99], v[56:59], a[72:75], v[96:99]
    v_mfma_f32_16x16x32_bf16 v[100:103], v[56:59], a[76:79], v[100:103]
    v_mfma_f32_16x16x32_bf16 v[84:87], v[52:55], a[80:83], v[84:87]
    v_perm_b32 v15, v22, v22, s57
    v_and_b32 v56, v15, v28
    v_and_b32 v57, v15, v29
    v_and_b32 v58, v15, v30
    v_and_b32 v59, v15, v31
    v_mfma_f32_16x16x32_bf16 v[88:91], v[52:55], a[84:87], v[88:91]
    v_mfma_f32_16x16x32_bf16 v[92:95], v[52:55], a[88:91], v[92:95]
    v_mfma_f32_16x16x32_bf16 v[96:99], v[52:55], a[92:95], v[96:99]
    v_mfma_f32_16x16x32_bf16 v[100:103], v[52:55], a[96:99], v[100:103]
    v_mfma_f32_16x16x32_bf16 v[84:87], v[56:59], a[100:103], v[84:87]
    v_perm_b32 v15, v23, v23, s56
    v_and_b32 v52, v15, v28
    v_and_b32 v53, v15, v29
    v_and_b32 v54, v15, v30
    v_and_b32 v55, v15, v31
    v_mfma_f32_16x16x32_bf16 v[88:91], v[56:59], a[104:107], v[88:91]
    v_mfma_f32_16x16x32_bf16 v[92:95], v[56:59], a[108:111], v[92:95]
    v_mfma_f32_16x16x32_bf16 v[96:99], v[56:59], a[112:115], v[96:99]
    v_mfma_f32_16x16x32_bf16 v[100:103], v[56:59], a[116:119], v[100:103]
    v_mfma_f32_16x16x32_bf16 v[84:87], v[52:55], a[120:123], v[84:87]
    v_perm_b32 v15, v23, v23, s57
    v_and_b32 v56, v15, v28
    v_and_b32 v57, v15, v29
    v_and_b32 v58, v15, v30
    v_and_b32 v59, v15, v31
    v_mfma_f32_16x16x32_bf16 v[88:91], v[52:55], a[124:127], v[88:91]
    v_mfma_f32_16x16x32_bf16 v[92:95], v[52:55], a[128:131], v[92:95]
    v_mfma_f32_16x16x32_bf16 v[96:99], v[52:55], a[132:135], v[96:99]
    v_mfma_f32_16x16x32_bf16 v[100:103], v[52:55], a[136:139], v[100:103]
    v_mfma_f32_16x16x32_bf16 v[84:87], v[56:59], a[140:143], v[84:87]
    v_perm_b32 v15, v24, v24, s56
    v_and_b32 v52, v15, v28
    v_and_b32 v53, v15, v29
    v_and_b32 v54, v15, v30
    v_and_b32 v55, v15, v31
    v_mfma_f32_16x16x32_bf16 v[88:91], v[56:59], a[144:147], v[88:91]
    v_mfma_f32_16x16x32_bf16 v[92:95], v[56:59], a[148:151], v[92:95]
    v_mfma_f32_16x16x32_bf16 v[96:99], v[56:59], a[152:155], v[96:99]
    v_mfma_f32_16x16x32_bf16 v[100:103], v[56:59], a[156:159], v[100:103]
    v_mfma_f32_16x16x32_bf16 v[84:87], v[52:55], a[160:163], v[84:87]
    v_perm_b32 v15, v24, v24, s57
    v_and_b32 v56, v15, v28
    v_and_b32 v57, v15, v29
    v_and_b32 v58, v15, v30
    v_and_b32 v59, v15, v31
    v_mfma_f32_16x16x32_bf16 v[88:91], v[52:55], a[164:167], v[88:91]
    v_mfma_f32_16x16x32_bf16 v[92:95], v[52:55], a[168:171], v[92:95]
    v_mfma_f32_16x16x32_bf16 v[96:99], v[52:55], a[172:175], v[96:99]
    v_mfma_f32_16x16x32_bf16 v[100:103], v[52:55], a[176:179], v[100:103]
    v_mfma_f32_16x16x32_bf16 v[84:87], v[56:59], a[180:183], v[84:87]
    v_perm_b32 v15, v25, v25, s56
    v_and_b32 v52, v15, v28
    v_and_b32 v53, v15, v29
    v_and_b32 v54, v15, v30
    v_and_b32 v55, v15, v31
    v_mfma_f32_16x16x32_bf16 v[88:91], v[56:59], a[184:187], v[88:91]
    v_mfma_f32_16x16x32_bf16 v[92:95], v[56:59], a[188:191], v[92:95]
    v_mfma_f32_16x16x32_bf16 v[96:99], v[56:59], a[192:195], v[96:99]
    v_mfma_f32_16x16x32_bf16 v[100:103], v[56:59], a[196:199], v[100:103]
    v_mfma_f32_16x16x32_bf16 v[84:87], v[52:55], a[200:203], v[84:87]
    v_perm_b32 v15, v25, v25, s57
    v_and_b32 v56, v15, v28
    v_and_b32 v57, v15, v29
    v_and_b32 v58, v15, v30
    v_and_b32 v59, v15, v31
    v_mfma_f32_16x16x32_bf16 v[88:91], v[52:55], a[204:207], v[88:91]
    v_mfma_f32_16x16x32_bf16 v[92:95], v[52:55], a[208:211], v[92:95]
    v_mfma_f32_16x16x32_bf16 v[96:99], v[52:55], a[212:215], v[96:99]
    v_mfma_f32_16x16x32_bf16 v[100:103], v[52:55], a[216:219], v[100:103]
    v_mfma_f32_16x16x32_bf16 v[84:87], v[56:59], a[220:223], v[84:87]
    v_mfma_f32_16x16x32_bf16 v[88:91], v[56:59], a[224:227], v[88:91]
    v_mfma_f32_16x16x32_bf16 v[92:95], v[56:59], a[228:231], v[92:95]
    v_mfma_f32_16x16x32_bf16 v[96:99], v[56:59], a[232:235], v[96:99]
    v_mfma_f32_16x16x32_bf16 v[100:103], v[56:59], a[236:239], v[100:103]
    v_mov_b32 v14, 8240
    s_cmp_lg_u32 s13, 0
    s_cbranch_scc1 L_notick2
    s_waitcnt vmcnt(0)
    s_mov_b64 exec, 1
    ds_write_b32 v14, v82
L_notick2:
    s_mov_b32 exec_lo, -1
    s_mov_b32 exec_hi, 0
    s_nop 0
    ds_write_b128 v79, v[84:87] offset:8448
    ds_write_b128 v79, v[88:91] offset:8960
    ds_write_b128 v79, v[92:95] offset:9472
    ds_write_b128 v79, v[96:99] offset:9984
    ds_write_b128 v79, v[100:103] offset:10496
    s_mov_b64 exec, -1
    s_waitcnt lgkmcnt(0)
    s_barrier
    ds_read_b32 v82, v14
    v_mov_b32 v13, 0xff
    s_movk_i32 exec_hi, 0xff
    ds_read_b128 v[84:87], v5 offset:8448
    ds_read_b128 v[88:91], v5 offset:11008
    ds_read_b128 v[92:95], v5 offset:13568
    ds_read_b128 v[96:99], v5 offset:16128
    s_waitcnt lgkmcnt(4)
    v_readfirstlane_b32 s45, v82
    s_cmp_eq_u32 s45, 31
    s_cbranch_scc1 L_last
    s_mul_i32 s51, s45, 640
    v_add_u32 v9, s51, v2
    s_waitcnt lgkmcnt(2)
    v_pk_add_f32 v[84:85], v[84:85], v[88:89]
    v_pk_add_f32 v[86:87], v[86:87], v[90:91]
    s_waitcnt lgkmcnt(1)
    v_pk_add_f32 v[84:85], v[84:85], v[92:93]
    v_pk_add_f32 v[86:87], v[86:87], v[94:95]
    s_waitcnt lgkmcnt(0)
    v_pk_add_f32 v[84:85], v[84:85], v[96:97]
    v_pk_add_f32 v[86:87], v[86:87], v[98:99]
    v_bfi_b32 v84, v13, s24, v84
    v_bfi_b32 v85, v13, s25, v85
    v_bfi_b32 v86, v13, s26, v86
    v_bfi_b32 v87, v13, s27, v87
    global_store_dwordx4 v9, v[84:87], s[40:41] sc1
    s_branch L_fin
L_last:
    s_mov_b64 exec, -1
    s_movk_i32 s90, 19840
    s_movk_i32 s51, 0
    buffer_load_dwordx4 v[132:135], v2, s[88:91], s51 offen offset:0 sc1
    buffer_load_dwordx4 v[136:139], v2, s[88:91], s51 offen offset:1024 sc1
    buffer_load_dwordx4 v[140:143], v2, s[88:91], s51 offen offset:2048 sc1
    buffer_load_dwordx4 v[144:147], v2, s[88:91], s51 offen offset:3072 sc1
    s_movk_i32 s51, 4096
    buffer_load_dwordx4 v[148:151], v2, s[88:91], s51 offen offset:0 sc1
    buffer_load_dwordx4 v[152:155], v2, s[88:91], s51 offen offset:1024 sc1
    buffer_load_dwordx4 v[156:159], v2, s[88:91], s51 offen offset:2048 sc1
    buffer_load_dwordx4 v[160:163], v2, s[88:91], s51 offen offset:3072 sc1
    s_movk_i32 s51, 8192
    buffer_load_dwordx4 v[164:167], v2, s[88:91], s51 offen offset:0 sc1
    buffer_load_dwordx4 v[168:171], v2, s[88:91], s51 offen offset:1024 sc1
    buffer_load_dwordx4 v[172:175], v2, s[88:91], s51 offen offset:2048 sc1
    buffer_load_dwordx4 v[176:179], v2, s[88:91], s51 offen offset:3072 sc1
    s_movk_i32 s51, 12288
    buffer_load_dwordx4 v[180:183], v2, s[88:91], s51 offen offset:0 sc1
    buffer_load_dwordx4 v[184:187], v2, s[88:91], s51 offen offset:1024 sc1
    buffer_load_dwordx4 v[188:191], v2, s[88:91], s51 offen offset:2048 sc1
    buffer_load_dwordx4 v[192:195], v2, s[88:91], s51 offen offset:3072 sc1
    s_movk_i32 s51, 16384
    buffer_load_dwordx4 v[196:199], v2, s[88:91], s51 offen offset:0 sc1
    buffer_load_dwordx4 v[200:203], v2, s[88:91], s51 offen offset:1024 sc1
    buffer_load_dwordx4 v[204:207], v2, s[88:91], s51 offen offset:2048 sc1
    buffer_load_dwordx4 v[208:211], v2, s[88:91], s51 offen offset:3072 sc1
    s_movk_i32 exec_hi, 0xff
    s_waitcnt lgkmcnt(2)
    v_pk_add_f32 v[84:85], v[84:85], v[88:89]
    v_pk_add_f32 v[86:87], v[86:87], v[90:91]
    s_waitcnt lgkmcnt(1)
    v_pk_add_f32 v[84:85], v[84:85], v[92:93]
    v_pk_add_f32 v[86:87], v[86:87], v[94:95]
    s_waitcnt lgkmcnt(0)
    v_pk_add_f32 v[84:85], v[84:85], v[96:97]
    v_pk_add_f32 v[86:87], v[86:87], v[98:99]
    s_mov_b64 exec, -1
    s_mul_i32 s4, s42, 2560
    s_mul_i32 s5, s44, 1280
    s_add_u32 s4, s4, s5
    v_lshrrev_b32 v9, 1, v5
    v_add_u32 v9, s4, v9
    v_mul_u32_u24 v8, 5120, v7
    v_add_u32 v8, v8, v2
    s_mov_b32 s45, 0x40000
L_checkA:
    s_waitcnt vmcnt(19)
    v_xor_b32 v132, s24, v132
    v_xor_b32 v133, s25, v133
    v_xor_b32 v134, s26, v134
    v_xor_b32 v135, s27, v135
    v_or_b32 v14, v132, v133
    v_or3_b32 v14, v134, v135, v14
    s_waitcnt vmcnt(18)
    v_xor_b32 v136, s24, v136
    v_xor_b32 v137, s25, v137
    v_xor_b32 v138, s26, v138
    v_xor_b32 v139, s27, v139
    v_or3_b32 v14, v136, v137, v14
    v_or3_b32 v14, v138, v139, v14
    s_waitcnt vmcnt(17)
    v_xor_b32 v140, s24, v140
    v_xor_b32 v141, s25, v141
    v_xor_b32 v142, s26, v142
    v_xor_b32 v143, s27, v143
    v_or3_b32 v14, v140, v141, v14
    v_or3_b32 v14, v142, v143, v14
    s_waitcnt vmcnt(16)
    v_xor_b32 v144, s24, v144
    v_xor_b32 v145, s25, v145
    v_xor_b32 v146, s26, v146
    v_xor_b32 v147, s27, v147
    v_or3_b32 v14, v144, v145, v14
    v_or3_b32 v14, v146, v147, v14
    s_waitcnt vmcnt(15)
    v_xor_b32 v148, s24, v148
    v_xor_b32 v149, s25, v149
    v_xor_b32 v150, s26, v150
    v_xor_b32 v151, s27, v151
    v_or3_b32 v14, v148, v149, v14
    v_or3_b32 v14, v150, v151, v14
    s_waitcnt vmcnt(14)
    v_xor_b32 v152, s24, v152
    v_xor_b32 v153, s25, v153
    v_xor_b32 v154, s26, v154
    v_xor_b32 v155, s27, v155
    v_or3_b32 v14, v152, v153, v14
    v_or3_b32 v14, v154, v155, v14
    v_pk_add_f32 v[100:101], v[132:133], v[152:153]
    v_pk_add_f32 v[102:103], v[134:135], v[154:155]
    s_waitcnt vmcnt(13)
    v_xor_b32 v156, s24, v156
    v_xor_b32 v157, s25, v157
    v_xor_b32 v158, s26, v158
    v_xor_b32 v159, s27, v159
    v_or3_b32 v14, v156, v157, v14
    v_or3_b32 v14, v158, v159, v14
    v_pk_add_f32 v[104:105], v[136:137], v[156:157]
    v_pk_add_f32 v[106:107], v[138:139], v[158:159]
    s_waitcnt vmcnt(12)
    v_xor_b32 v160, s24, v160
    v_xor_b32 v161, s25, v161
    v_xor_b32 v162, s26, v162
    v_xor_b32 v163, s27, v163
    v_or3_b32 v14, v160, v161, v14
    v_or3_b32 v14, v162, v163, v14
    v_pk_add_f32 v[108:109], v[140:141], v[160:161]
    v_pk_add_f32 v[110:111], v[142:143], v[162:163]
    s_waitcnt vmcnt(11)
    v_xor_b32 v164, s24, v164
    v_xor_b32 v165, s25, v165
    v_xor_b32 v166, s26, v166
    v_xor_b32 v167, s27, v167
    v_or3_b32 v14, v164, v165, v14
    v_or3_b32 v14, v166, v167, v14
    v_pk_add_f32 v[112:113], v[144:145], v[164:165]
    v_pk_add_f32 v[114:115], v[146:147], v[166:167]
    s_waitcnt vmcnt(10)
    v_xor_b32 v168, s24, v168
    v_xor_b32 v169, s25, v169
    v_xor_b32 v170, s26, v170
    v_xor_b32 v171, s27, v171
    v_or3_b32 v14, v168, v169, v14
    v_or3_b32 v14, v170, v171, v14
    v_pk_add_f32 v[116:117], v[148:149], v[168:169]
    v_pk_add_f32 v[118:119], v[150:151], v[170:171]
    s_waitcnt vmcnt(9)
    v_xor_b32 v172, s24, v172
    v_xor_b32 v173, s25, v173
    v_xor_b32 v174, s26, v174
    v_xor_b32 v175, s27, v175
    v_or3_b32 v14, v172, v173, v14
    v_or3_b32 v14, v174, v175, v14
    v_pk_add_f32 v[100:101], v[100:101], v[172:173]
    v_pk_add_f32 v[102:103], v[102:103], v[174:175]
    s_waitcnt vmcnt(8)
    v_xor_b32 v176, s24, v176
    v_xor_b32 v177, s25, v177
    v_xor_b32 v178, s26, v178
    v_xor_b32 v179, s27, v179
    v_or3_b32 v14, v176, v177, v14
    v_or3_b32 v14, v178, v179, v14
    v_pk_add_f32 v[104:105], v[104:105], v[176:177]
    v_pk_add_f32 v[106:107], v[106:107], v[178:179]
    s_waitcnt vmcnt(7)
    v_xor_b32 v180, s24, v180
    v_xor_b32 v181, s25, v181
    v_xor_b32 v182, s26, v182
    v_xor_b32 v183, s27, v183
    v_or3_b32 v14, v180, v181, v14
    v_or3_b32 v14, v182, v183, v14
    v_pk_add_f32 v[108:109], v[108:109], v[180:181]
    v_pk_add_f32 v[110:111], v[110:111], v[182:183]
    s_waitcnt vmcnt(6)
    v_xor_b32 v184, s24, v184
    v_xor_b32 v185, s25, v185
    v_xor_b32 v186, s26, v186
    v_xor_b32 v187, s27, v187
    v_or3_b32 v14, v184, v185, v14
    v_or3_b32 v14, v186, v187, v14
    v_pk_add_f32 v[112:113], v[112:113], v[184:185]
    v_pk_add_f32 v[114:115], v[114:115], v[186:187]
    s_waitcnt vmcnt(5)
    v_xor_b32 v188, s24, v188
    v_xor_b32 v189, s25, v189
    v_xor_b32 v190, s26, v190
    v_xor_b32 v191, s27, v191
    v_or3_b32 v14, v188, v189, v14
    v_or3_b32 v14, v190, v191, v14
    v_pk_add_f32 v[116:117], v[116:117], v[188:189]
    v_pk_add_f32 v[118:119], v[118:119], v[190:191]
    v_and_b32 v14, v13, v14
    v_cmp_ne_u32 vcc, 0, v14
    s_cbranch_vccz L_checkB
    s_sub_u32 s45, s45, 1
    s_cmp_eq_u32 s45, 0
    s_cbranch_scc1 L_checkB
    s_waitcnt vmcnt(0)
    s_movk_i32 s51, 0
    buffer_load_dwordx4 v[132:135], v2, s[88:91], s51 offen offset:0 sc1
    buffer_load_dwordx4 v[136:139], v2, s[88:91], s51 offen offset:1024 sc1
    buffer_load_dwordx4 v[140:143], v2, s[88:91], s51 offen offset:2048 sc1
    buffer_load_dwordx4 v[144:147], v2, s[88:91], s51 offen offset:3072 sc1
    s_movk_i32 s51, 4096
    buffer_load_dwordx4 v[148:151], v2, s[88:91], s51 offen offset:0 sc1
    buffer_load_dwordx4 v[152:155], v2, s[88:91], s51 offen offset:1024 sc1
    buffer_load_dwordx4 v[156:159], v2, s[88:91], s51 offen offset:2048 sc1
    buffer_load_dwordx4 v[160:163], v2, s[88:91], s51 offen offset:3072 sc1
    s_movk_i32 s51, 8192
    buffer_load_dwordx4 v[164:167], v2, s[88:91], s51 offen offset:0 sc1
    buffer_load_dwordx4 v[168:171], v2, s[88:91], s51 offen offset:1024 sc1
    buffer_load_dwordx4 v[172:175], v2, s[88:91], s51 offen offset:2048 sc1
    buffer_load_dwordx4 v[176:179], v2, s[88:91], s51 offen offset:3072 sc1
    s_movk_i32 s51, 12288
    buffer_load_dwordx4 v[180:183], v2, s[88:91], s51 offen offset:0 sc1
    buffer_load_dwordx4 v[184:187], v2, s[88:91], s51 offen offset:1024 sc1
    buffer_load_dwordx4 v[188:191], v2, s[88:91], s51 offen offset:2048 sc1
    buffer_load_dwordx4 v[192:195], v2, s[88:91], s51 offen offset:3072 sc1
    s_movk_i32 s51, 16384
    buffer_load_dwordx4 v[196:199], v2, s[88:91], s51 offen offset:0 sc1
    buffer_load_dwordx4 v[200:203], v2, s[88:91], s51 offen offset:1024 sc1
    buffer_load_dwordx4 v[204:207], v2, s[88:91], s51 offen offset:2048 sc1
    buffer_load_dwordx4 v[208:211], v2, s[88:91], s51 offen offset:3072 sc1
    s_branch L_checkA
L_checkB:
    s_waitcnt vmcnt(4)
    v_xor_b32 v192, s24, v192
    v_xor_b32 v193, s25, v193
    v_xor_b32 v194, s26, v194
    v_xor_b32 v195, s27, v195
    v_or_b32 v14, v192, v193
    v_or3_b32 v14, v194, v195, v14
    s_waitcnt vmcnt(3)
    v_xor_b32 v196, s24, v196
    v_xor_b32 v197, s25, v197
    v_xor_b32 v198, s26, v198
    v_xor_b32 v199, s27, v199
    v_or3_b32 v14, v196, v197, v14
    v_or3_b32 v14, v198, v199, v14
    s_waitcnt vmcnt(2)
    v_xor_b32 v200, s24, v200
    v_xor_b32 v201, s25, v201
    v_xor_b32 v202, s26, v202
    v_xor_b32 v203, s27, v203
    v_or3_b32 v14, v200, v201, v14
    v_or3_b32 v14, v202, v203, v14
    s_waitcnt vmcnt(1)
    v_xor_b32 v204, s24, v204
    v_xor_b32 v205, s25, v205
    v_xor_b32 v206, s26, v206
    v_xor_b32 v207, s27, v207
    v_or3_b32 v14, v204, v205, v14
    v_or3_b32 v14, v206, v207, v14
    s_waitcnt vmcnt(0)
    s_mov_b64 exec, 0xffffff
    v_xor_b32 v208, s24, v208
    v_xor_b32 v209, s25, v209
    v_xor_b32 v210, s26, v210
    v_xor_b32 v211, s27, v211
    v_or3_b32 v14, v208, v209, v14
    v_or3_b32 v14, v210, v211, v14
    s_mov_b64 exec, -1
    v_and_b32 v14, v13, v14
    v_cmp_ne_u32 vcc, 0, v14
    s_cbranch_vccz L_sum
    s_sub_u32 s45, s45, 1
    s_cmp_lt_i32 s45, 1
    s_cbranch_scc1 L_sum
    s_movk_i32 s51, 12288
    buffer_load_dwordx4 v[192:195], v2, s[88:91], s51 offen offset:3072 sc1
    s_movk_i32 s51, 16384
    buffer_load_dwordx4 v[196:199], v2, s[88:91], s51 offen offset:0 sc1
    buffer_load_dwordx4 v[200:203], v2, s[88:91], s51 offen offset:1024 sc1
    buffer_load_dwordx4 v[204:207], v2, s[88:91], s51 offen offset:2048 sc1
    buffer_load_dwordx4 v[208:211], v2, s[88:91], s51 offen offset:3072 sc1
    s_branch L_checkB
L_sum:
    v_pk_add_f32 v[100:101], v[100:101], v[192:193]
    v_pk_add_f32 v[102:103], v[102:103], v[194:195]
    ds_write_b128 v8, v[100:103] offset:36864
    v_pk_add_f32 v[104:105], v[104:105], v[196:197]
    v_pk_add_f32 v[106:107], v[106:107], v[198:199]
    ds_write_b128 v8, v[104:107] offset:37888
    v_pk_add_f32 v[108:109], v[108:109], v[200:201]
    v_pk_add_f32 v[110:111], v[110:111], v[202:203]
    ds_write_b128 v8, v[108:111] offset:38912
    v_pk_add_f32 v[112:113], v[112:113], v[204:205]
    v_pk_add_f32 v[114:115], v[114:115], v[206:207]
    ds_write_b128 v8, v[112:115] offset:39936
    v_pk_add_f32 v[116:117], v[116:117], v[208:209]
    v_pk_add_f32 v[118:119], v[118:119], v[210:211]
    ds_write_b128 v8, v[116:119] offset:40960
    s_movk_i32 exec_hi, 0xff
    ds_read_b128 v[132:135], v8 offset:36864
    ds_read_b128 v[136:139], v8 offset:37504
    ds_read_b128 v[140:143], v8 offset:38144
    ds_read_b128 v[144:147], v8 offset:38784
    ds_read_b128 v[148:151], v8 offset:39424
    ds_read_b128 v[152:155], v8 offset:40064
    ds_read_b128 v[156:159], v8 offset:40704
    ds_read_b128 v[160:163], v8 offset:41344
    s_waitcnt lgkmcnt(6)
    v_pk_add_f32 v[132:133], v[132:133], v[136:137]
    v_pk_add_f32 v[134:135], v[134:135], v[138:139]
    s_waitcnt lgkmcnt(5)
    v_pk_add_f32 v[132:133], v[132:133], v[140:141]
    v_pk_add_f32 v[134:135], v[134:135], v[142:143]
    s_waitcnt lgkmcnt(4)
    v_pk_add_f32 v[132:133], v[132:133], v[144:145]
    v_pk_add_f32 v[134:135], v[134:135], v[146:147]
    s_waitcnt lgkmcnt(3)
    v_pk_add_f32 v[132:133], v[132:133], v[148:149]
    v_pk_add_f32 v[134:135], v[134:135], v[150:151]
    s_waitcnt lgkmcnt(2)
    v_pk_add_f32 v[132:133], v[132:133], v[152:153]
    v_pk_add_f32 v[134:135], v[134:135], v[154:155]
    s_waitcnt lgkmcnt(1)
    v_pk_add_f32 v[132:133], v[132:133], v[156:157]
    v_pk_add_f32 v[134:135], v[134:135], v[158:159]
    s_waitcnt lgkmcnt(0)
    v_pk_add_f32 v[132:133], v[132:133], v[160:161]
    v_pk_add_f32 v[134:135], v[134:135], v[162:163]
    v_pk_add_f32 v[132:133], v[132:133], v[84:85]
    v_pk_add_f32 v[134:135], v[134:135], v[86:87]
L_ready:
    v_cvt_pk_bf16_f32 v14, v132, v133
    v_cvt_pk_bf16_f32 v15, v134, v135
    global_store_dwordx2 v9, v[14:15], s[36:37]
L_fin:
L_end:
    s_endpgm
L_kblock:
    s_barrier
    s_memrealtime s[4:5]
    s_waitcnt lgkmcnt(0)
    s_call_b64 s[84:85], L_anchor
    s_sub_u32 s4, s4, s80
    s_add_u32 s80, s80, s82
    s_cmp_lt_i32 s4, -50
    s_cbranch_scc1 L_kb0
    s_cmp_lt_i32 s4, 50
    s_cbranch_scc1 L_kb1
L_kb2:
    s_mov_b32 s81, 2
    s_waitcnt vmcnt(16)
    v_mfma_f32_16x16x32_bf16 v[44:47], v[84:87], v[20:23], 0
    buffer_load_dwordx4 v[84:87], v5, s[16:19], s47 offen offset:0 nt
    s_waitcnt vmcnt(16)
    v_mfma_f32_16x16x32_bf16 v[44:47], v[88:91], v[24:27], v[44:47]
    buffer_load_dwordx4 v[88:91], v5, s[16:19], s47 offen offset:128 nt
    s_waitcnt vmcnt(16)
    v_mfma_f32_16x16x32_bf16 v[44:47], v[92:95], v[28:31], v[44:47]
    buffer_load_dwordx4 v[92:95], v5, s[16:19], s47 offen offset:256 nt
    s_add_u32 s86, s86, 4
    s_cmp_ge_u32 s86, 63
    s_cselect_b32 s3, 63, 0
    s_cselect_b32 s4, 196608, 0
    s_sub_u32 s86, s86, s3
    s_add_u32 s87, s87, s4
    s_cmp_eq_u32 s87, s18
    s_cselect_b32 s87, 0, s87
    s_mul_i32 s3, s86, 49
    s_lshr_b32 s3, s3, 10
    s_mul_i32 s3, s3, 33408
    s_mul_i32 s47, s86, 1536
    s_add_u32 s3, s3, s87
    s_add_u32 s47, s47, s3
    v_add_u32 v80, -4, v80
    v_mov_b32_dpp v14, v48 quad_perm:[0,0,0,0] row_mask:0xf bank_mask:0xf
    v_add_f32_dpp v14, v49, v14 quad_perm:[1,1,1,1] row_mask:0xf bank_mask:0xf
    v_add_f32_dpp v14, v50, v14 quad_perm:[2,2,2,2] row_mask:0xf bank_mask:0xf
    v_add_f32_dpp v14, v51, v14 quad_perm:[3,3,3,3] row_mask:0xf bank_mask:0xf
    ds_write_b32 v80, v14 offset:0
    s_waitcnt vmcnt(16)
    v_mfma_f32_16x16x32_bf16 v[48:51], v[96:99], v[20:23], 0
    buffer_load_dwordx4 v[96:99], v5, s[16:19], s47 offen offset:0 nt
    s_waitcnt vmcnt(16)
    v_mfma_f32_16x16x32_bf16 v[48:51], v[100:103], v[24:27], v[48:51]
    buffer_load_dwordx4 v[100:103], v5, s[16:19], s47 offen offset:128 nt
    s_waitcnt vmcnt(16)
    v_mfma_f32_16x16x32_bf16 v[48:51], v[104:107], v[28:31], v[48:51]
    buffer_load_dwordx4 v[104:107], v5, s[16:19], s47 offen offset:256 nt
    s_add_u32 s86, s86, 4
    s_cmp_ge_u32 s86, 63
    s_cselect_b32 s3, 63, 0
    s_cselect_b32 s4, 196608, 0
    s_sub_u32 s86, s86, s3
    s_add_u32 s87, s87, s4
    s_cmp_eq_u32 s87, s18
    s_cselect_b32 s87, 0, s87
    s_mul_i32 s3, s86, 49
    s_lshr_b32 s3, s3, 10
    s_mul_i32 s3, s3, 33408
    s_mul_i32 s47, s86, 1536
    s_add_u32 s3, s3, s87
    s_add_u32 s47, s47, s3
    v_mov_b32_dpp v14, v44 quad_perm:[0,0,0,0] row_mask:0xf bank_mask:0xf
    v_add_f32_dpp v14, v45, v14 quad_perm:[1,1,1,1] row_mask:0xf bank_mask:0xf
    v_add_f32_dpp v14, v46, v14 quad_perm:[2,2,2,2] row_mask:0xf bank_mask:0xf
    v_add_f32_dpp v14, v47, v14 quad_perm:[3,3,3,3] row_mask:0xf bank_mask:0xf
    ds_write_b32 v80, v14 offset:4
    s_waitcnt vmcnt(16)
    v_mfma_f32_16x16x32_bf16 v[44:47], v[108:111], v[20:23], 0
    buffer_load_dwordx4 v[108:111], v5, s[16:19], s47 offen offset:0 nt
    s_waitcnt vmcnt(16)
    v_mfma_f32_16x16x32_bf16 v[44:47], v[112:115], v[24:27], v[44:47]
    buffer_load_dwordx4 v[112:115], v5, s[16:19], s47 offen offset:128 nt
    s_waitcnt vmcnt(16)
    v_mfma_f32_16x16x32_bf16 v[44:47], v[116:119], v[28:31], v[44:47]
    buffer_load_dwordx4 v[116:119], v5, s[16:19], s47 offen offset:256 nt
    s_add_u32 s86, s86, 4
    s_cmp_ge_u32 s86, 63
    s_cselect_b32 s3, 63, 0
    s_cselect_b32 s4, 196608, 0
    s_sub_u32 s86, s86, s3
    s_add_u32 s87, s87, s4
    s_cmp_eq_u32 s87, s18
    s_cselect_b32 s87, 0, s87
    s_mul_i32 s3, s86, 49
    s_lshr_b32 s3, s3, 10
    s_mul_i32 s3, s3, 33408
    s_mul_i32 s47, s86, 1536
    s_add_u32 s3, s3, s87
    s_add_u32 s47, s47, s3
    v_mov_b32_dpp v14, v48 quad_perm:[0,0,0,0] row_mask:0xf bank_mask:0xf
    v_add_f32_dpp v14, v49, v14 quad_perm:[1,1,1,1] row_mask:0xf bank_mask:0xf
    v_add_f32_dpp v14, v50, v14 quad_perm:[2,2,2,2] row_mask:0xf bank_mask:0xf
    v_add_f32_dpp v14, v51, v14 quad_perm:[3,3,3,3] row_mask:0xf bank_mask:0xf
    ds_write_b32 v80, v14 offset:8
    s_waitcnt vmcnt(16)
    v_mfma_f32_16x16x32_bf16 v[48:51], v[120:123], v[20:23], 0
    buffer_load_dwordx4 v[120:123], v5, s[16:19], s47 offen offset:0 nt
    s_waitcnt vmcnt(16)
    v_mfma_f32_16x16x32_bf16 v[48:51], v[124:127], v[24:27], v[48:51]
    buffer_load_dwordx4 v[124:127], v5, s[16:19], s47 offen offset:128 nt
    s_waitcnt vmcnt(16)
    v_mfma_f32_16x16x32_bf16 v[48:51], v[128:131], v[28:31], v[48:51]
    buffer_load_dwordx4 v[128:131], v5, s[16:19], s47 offen offset:256 nt
    s_add_u32 s86, s86, 4
    s_cmp_ge_u32 s86, 63
    s_cselect_b32 s3, 63, 0
    s_cselect_b32 s4, 196608, 0
    s_sub_u32 s86, s86, s3
    s_add_u32 s87, s87, s4
    s_cmp_eq_u32 s87, s18
    s_cselect_b32 s87, 0, s87
    s_mul_i32 s3, s86, 49
    s_lshr_b32 s3, s3, 10
    s_mul_i32 s3, s3, 33408
    s_mul_i32 s47, s86, 1536
    s_add_u32 s3, s3, s87
    s_add_u32 s47, s47, s3
    v_mov_b32_dpp v14, v44 quad_perm:[0,0,0,0] row_mask:0xf bank_mask:0xf
    v_add_f32_dpp v14, v45, v14 quad_perm:[1,1,1,1] row_mask:0xf bank_mask:0xf
    v_add_f32_dpp v14, v46, v14 quad_perm:[2,2,2,2] row_mask:0xf bank_mask:0xf
    v_add_f32_dpp v14, v47, v14 quad_perm:[3,3,3,3] row_mask:0xf bank_mask:0xf
    ds_write_b32 v80, v14 offset:12
    s_setpc_b64 s[58:59]
L_kb1:
    s_mov_b32 s81, 1
    s_waitcnt vmcnt(10)
    v_mfma_f32_16x16x32_bf16 v[44:47], v[84:87], v[20:23], 0
    buffer_load_dwordx4 v[84:87], v5, s[16:19], s47 offen offset:0 nt
    s_waitcnt vmcnt(10)
    v_mfma_f32_16x16x32_bf16 v[44:47], v[88:91], v[24:27], v[44:47]
    buffer_load_dwordx4 v[88:91], v5, s[16:19], s47 offen offset:128 nt
    s_waitcnt vmcnt(10)
    v_mfma_f32_16x16x32_bf16 v[44:47], v[92:95], v[28:31], v[44:47]
    buffer_load_dwordx4 v[92:95], v5, s[16:19], s47 offen offset:256 nt
    s_add_u32 s86, s86, 4
    s_cmp_ge_u32 s86, 63
    s_cselect_b32 s3, 63, 0
    s_cselect_b32 s4, 196608, 0
    s_sub_u32 s86, s86, s3
    s_add_u32 s87, s87, s4
    s_cmp_eq_u32 s87, s18
    s_cselect_b32 s87, 0, s87
    s_mul_i32 s3, s86, 49
    s_lshr_b32 s3, s3, 10
    s_mul_i32 s3, s3, 33408
    s_mul_i32 s47, s86, 1536
    s_add_u32 s3, s3, s87
    s_add_u32 s47, s47, s3
    v_add_u32 v80, -4, v80
    v_mov_b32_dpp v14, v48 quad_perm:[0,0,0,0] row_mask:0xf bank_mask:0xf
    v_add_f32_dpp v14, v49, v14 quad_perm:[1,1,1,1] row_mask:0xf bank_mask:0xf
    v_add_f32_dpp v14, v50, v14 quad_perm:[2,2,2,2] row_mask:0xf bank_mask:0xf
    v_add_f32_dpp v14, v51, v14 quad_perm:[3,3,3,3] row_mask:0xf bank_mask:0xf
    ds_write_b32 v80, v14 offset:0
    s_waitcnt vmcnt(10)
    v_mfma_f32_16x16x32_bf16 v[48:51], v[96:99], v[20:23], 0
    buffer_load_dwordx4 v[96:99], v5, s[16:19], s47 offen offset:0 nt
    s_waitcnt vmcnt(10)
    v_mfma_f32_16x16x32_bf16 v[48:51], v[100:103], v[24:27], v[48:51]
    buffer_load_dwordx4 v[100:103], v5, s[16:19], s47 offen offset:128 nt
    s_waitcnt vmcnt(10)
    v_mfma_f32_16x16x32_bf16 v[48:51], v[104:107], v[28:31], v[48:51]
    buffer_load_dwordx4 v[104:107], v5, s[16:19], s47 offen offset:256 nt
    s_add_u32 s86, s86, 4
    s_cmp_ge_u32 s86, 63
    s_cselect_b32 s3, 63, 0
    s_cselect_b32 s4, 196608, 0
    s_sub_u32 s86, s86, s3
    s_add_u32 s87, s87, s4
    s_cmp_eq_u32 s87, s18
    s_cselect_b32 s87, 0, s87
    s_mul_i32 s3, s86, 49
    s_lshr_b32 s3, s3, 10
    s_mul_i32 s3, s3, 33408
    s_mul_i32 s47, s86, 1536
    s_add_u32 s3, s3, s87
    s_add_u32 s47, s47, s3
    v_mov_b32_dpp v14, v44 quad_perm:[0,0,0,0] row_mask:0xf bank_mask:0xf
    v_add_f32_dpp v14, v45, v14 quad_perm:[1,1,1,1] row_mask:0xf bank_mask:0xf
    v_add_f32_dpp v14, v46, v14 quad_perm:[2,2,2,2] row_mask:0xf bank_mask:0xf
    v_add_f32_dpp v14, v47, v14 quad_perm:[3,3,3,3] row_mask:0xf bank_mask:0xf
    ds_write_b32 v80, v14 offset:4
    s_waitcnt vmcnt(5)
    v_mfma_f32_16x16x32_bf16 v[44:47], v[108:111], v[20:23], 0
    buffer_load_dwordx4 v[108:111], v5, s[16:19], s47 offen offset:0 nt
    s_waitcnt vmcnt(5)
    v_mfma_f32_16x16x32_bf16 v[44:47], v[112:115], v[24:27], v[44:47]
    buffer_load_dwordx4 v[112:115], v5, s[16:19], s47 offen offset:128 nt
    s_waitcnt vmcnt(5)
    v_mfma_f32_16x16x32_bf16 v[44:47], v[116:119], v[28:31], v[44:47]
    buffer_load_dwordx4 v[116:119], v5, s[16:19], s47 offen offset:256 nt
    s_add_u32 s86, s86, 4
    s_cmp_ge_u32 s86, 63
    s_cselect_b32 s3, 63, 0
    s_cselect_b32 s4, 196608, 0
    s_sub_u32 s86, s86, s3
    s_add_u32 s87, s87, s4
    s_cmp_eq_u32 s87, s18
    s_cselect_b32 s87, 0, s87
    s_mul_i32 s3, s86, 49
    s_lshr_b32 s3, s3, 10
    s_mul_i32 s3, s3, 33408
    s_mul_i32 s47, s86, 1536
    s_add_u32 s3, s3, s87
    s_add_u32 s47, s47, s3
    v_mov_b32_dpp v14, v48 quad_perm:[0,0,0,0] row_mask:0xf bank_mask:0xf
    v_add_f32_dpp v14, v49, v14 quad_perm:[1,1,1,1] row_mask:0xf bank_mask:0xf
    v_add_f32_dpp v14, v50, v14 quad_perm:[2,2,2,2] row_mask:0xf bank_mask:0xf
    v_add_f32_dpp v14, v51, v14 quad_perm:[3,3,3,3] row_mask:0xf bank_mask:0xf
    ds_write_b32 v80, v14 offset:8
    s_waitcnt vmcnt(5)
    v_mfma_f32_16x16x32_bf16 v[48:51], v[120:123], v[20:23], 0
    buffer_load_dwordx4 v[120:123], v5, s[16:19], s47 offen offset:0 nt
    s_waitcnt vmcnt(5)
    v_mfma_f32_16x16x32_bf16 v[48:51], v[124:127], v[24:27], v[48:51]
    buffer_load_dwordx4 v[124:127], v5, s[16:19], s47 offen offset:128 nt
    s_waitcnt vmcnt(5)
    v_mfma_f32_16x16x32_bf16 v[48:51], v[128:131], v[28:31], v[48:51]
    buffer_load_dwordx4 v[128:131], v5, s[16:19], s47 offen offset:256 nt
    s_add_u32 s86, s86, 4
    s_cmp_ge_u32 s86, 63
    s_cselect_b32 s3, 63, 0
    s_cselect_b32 s4, 196608, 0
    s_sub_u32 s86, s86, s3
    s_add_u32 s87, s87, s4
    s_cmp_eq_u32 s87, s18
    s_cselect_b32 s87, 0, s87
    s_mul_i32 s3, s86, 49
    s_lshr_b32 s3, s3, 10
    s_mul_i32 s3, s3, 33408
    s_mul_i32 s47, s86, 1536
    s_add_u32 s3, s3, s87
    s_add_u32 s47, s47, s3
    v_mov_b32_dpp v14, v44 quad_perm:[0,0,0,0] row_mask:0xf bank_mask:0xf
    v_add_f32_dpp v14, v45, v14 quad_perm:[1,1,1,1] row_mask:0xf bank_mask:0xf
    v_add_f32_dpp v14, v46, v14 quad_perm:[2,2,2,2] row_mask:0xf bank_mask:0xf
    v_add_f32_dpp v14, v47, v14 quad_perm:[3,3,3,3] row_mask:0xf bank_mask:0xf
    ds_write_b32 v80, v14 offset:12
    s_setpc_b64 s[58:59]
L_kb0:
    s_mov_b32 s81, 0
    s_waitcnt vmcnt(9)
    v_mfma_f32_16x16x32_bf16 v[44:47], v[84:87], v[20:23], 0
    buffer_load_dwordx4 v[84:87], v5, s[16:19], s47 offen offset:0 nt
    s_waitcnt vmcnt(9)
    v_mfma_f32_16x16x32_bf16 v[44:47], v[88:91], v[24:27], v[44:47]
    buffer_load_dwordx4 v[88:91], v5, s[16:19], s47 offen offset:128 nt
    s_waitcnt vmcnt(9)
    v_mfma_f32_16x16x32_bf16 v[44:47], v[92:95], v[28:31], v[44:47]
    buffer_load_dwordx4 v[92:95], v5, s[16:19], s47 offen offset:256 nt
    s_add_u32 s86, s86, 4
    s_cmp_ge_u32 s86, 63
    s_cselect_b32 s3, 63, 0
    s_cselect_b32 s4, 196608, 0
    s_sub_u32 s86, s86, s3
    s_add_u32 s87, s87, s4
    s_cmp_eq_u32 s87, s18
    s_cselect_b32 s87, 0, s87
    s_mul_i32 s3, s86, 49
    s_lshr_b32 s3, s3, 10
    s_mul_i32 s3, s3, 33408
    s_mul_i32 s47, s86, 1536
    s_add_u32 s3, s3, s87
    s_add_u32 s47, s47, s3
    v_add_u32 v80, -4, v80
    v_mov_b32_dpp v14, v48 quad_perm:[0,0,0,0] row_mask:0xf bank_mask:0xf
    v_add_f32_dpp v14, v49, v14 quad_perm:[1,1,1,1] row_mask:0xf bank_mask:0xf
    v_add_f32_dpp v14, v50, v14 quad_perm:[2,2,2,2] row_mask:0xf bank_mask:0xf
    v_add_f32_dpp v14, v51, v14 quad_perm:[3,3,3,3] row_mask:0xf bank_mask:0xf
    ds_write_b32 v80, v14 offset:0
    s_waitcnt vmcnt(9)
    v_mfma_f32_16x16x32_bf16 v[48:51], v[96:99], v[20:23], 0
    buffer_load_dwordx4 v[96:99], v5, s[16:19], s47 offen offset:0 nt
    s_waitcnt vmcnt(9)
    v_mfma_f32_16x16x32_bf16 v[48:51], v[100:103], v[24:27], v[48:51]
    buffer_load_dwordx4 v[100:103], v5, s[16:19], s47 offen offset:128 nt
    s_waitcnt vmcnt(4)
    v_mfma_f32_16x16x32_bf16 v[48:51], v[104:107], v[28:31], v[48:51]
    buffer_load_dwordx4 v[104:107], v5, s[16:19], s47 offen offset:256 nt
    s_add_u32 s86, s86, 4
    s_cmp_ge_u32 s86, 63
    s_cselect_b32 s3, 63, 0
    s_cselect_b32 s4, 196608, 0
    s_sub_u32 s86, s86, s3
    s_add_u32 s87, s87, s4
    s_cmp_eq_u32 s87, s18
    s_cselect_b32 s87, 0, s87
    s_mul_i32 s3, s86, 49
    s_lshr_b32 s3, s3, 10
    s_mul_i32 s3, s3, 33408
    s_mul_i32 s47, s86, 1536
    s_add_u32 s3, s3, s87
    s_add_u32 s47, s47, s3
    v_mov_b32_dpp v14, v44 quad_perm:[0,0,0,0] row_mask:0xf bank_mask:0xf
    v_add_f32_dpp v14, v45, v14 quad_perm:[1,1,1,1] row_mask:0xf bank_mask:0xf
    v_add_f32_dpp v14, v46, v14 quad_perm:[2,2,2,2] row_mask:0xf bank_mask:0xf
    v_add_f32_dpp v14, v47, v14 quad_perm:[3,3,3,3] row_mask:0xf bank_mask:0xf
    ds_write_b32 v80, v14 offset:4
    s_waitcnt vmcnt(4)
    v_mfma_f32_16x16x32_bf16 v[44:47], v[108:111], v[20:23], 0
    buffer_load_dwordx4 v[108:111], v5, s[16:19], s47 offen offset:0 nt
    s_waitcnt vmcnt(4)
    v_mfma_f32_16x16x32_bf16 v[44:47], v[112:115], v[24:27], v[44:47]
    buffer_load_dwordx4 v[112:115], v5, s[16:19], s47 offen offset:128 nt
    s_waitcnt vmcnt(4)
    v_mfma_f32_16x16x32_bf16 v[44:47], v[116:119], v[28:31], v[44:47]
    buffer_load_dwordx4 v[116:119], v5, s[16:19], s47 offen offset:256 nt
    s_add_u32 s86, s86, 4
    s_cmp_ge_u32 s86, 63
    s_cselect_b32 s3, 63, 0
    s_cselect_b32 s4, 196608, 0
    s_sub_u32 s86, s86, s3
    s_add_u32 s87, s87, s4
    s_cmp_eq_u32 s87, s18
    s_cselect_b32 s87, 0, s87
    s_mul_i32 s3, s86, 49
    s_lshr_b32 s3, s3, 10
    s_mul_i32 s3, s3, 33408
    s_mul_i32 s47, s86, 1536
    s_add_u32 s3, s3, s87
    s_add_u32 s47, s47, s3
    v_mov_b32_dpp v14, v48 quad_perm:[0,0,0,0] row_mask:0xf bank_mask:0xf
    v_add_f32_dpp v14, v49, v14 quad_perm:[1,1,1,1] row_mask:0xf bank_mask:0xf
    v_add_f32_dpp v14, v50, v14 quad_perm:[2,2,2,2] row_mask:0xf bank_mask:0xf
    v_add_f32_dpp v14, v51, v14 quad_perm:[3,3,3,3] row_mask:0xf bank_mask:0xf
    ds_write_b32 v80, v14 offset:8
    s_waitcnt vmcnt(4)
    v_mfma_f32_16x16x32_bf16 v[48:51], v[120:123], v[20:23], 0
    buffer_load_dwordx4 v[120:123], v5, s[16:19], s47 offen offset:0 nt
    s_waitcnt vmcnt(4)
    v_mfma_f32_16x16x32_bf16 v[48:51], v[124:127], v[24:27], v[48:51]
    buffer_load_dwordx4 v[124:127], v5, s[16:19], s47 offen offset:128 nt
    s_waitcnt vmcnt(4)
    v_mfma_f32_16x16x32_bf16 v[48:51], v[128:131], v[28:31], v[48:51]
    buffer_load_dwordx4 v[128:131], v5, s[16:19], s47 offen offset:256 nt
    s_add_u32 s86, s86, 4
    s_cmp_ge_u32 s86, 63
    s_cselect_b32 s3, 63, 0
    s_cselect_b32 s4, 196608, 0
    s_sub_u32 s86, s86, s3
    s_add_u32 s87, s87, s4
    s_cmp_eq_u32 s87, s18
    s_cselect_b32 s87, 0, s87
    s_mul_i32 s3, s86, 49
    s_lshr_b32 s3, s3, 10
    s_mul_i32 s3, s3, 33408
    s_mul_i32 s47, s86, 1536
    s_add_u32 s3, s3, s87
    s_add_u32 s47, s47, s3
    v_mov_b32_dpp v14, v44 quad_perm:[0,0,0,0] row_mask:0xf bank_mask:0xf
    v_add_f32_dpp v14, v45, v14 quad_perm:[1,1,1,1] row_mask:0xf bank_mask:0xf
    v_add_f32_dpp v14, v46, v14 quad_perm:[2,2,2,2] row_mask:0xf bank_mask:0xf
    v_add_f32_dpp v14, v47, v14 quad_perm:[3,3,3,3] row_mask:0xf bank_mask:0xf
    ds_write_b32 v80, v14 offset:12
    s_setpc_b64 s[58:59]
L_kblock2:
    s_cmp_eq_u32 s81, 0
    s_cbranch_scc1 L_kc0
    s_cmp_eq_u32 s81, 1
    s_cbranch_scc1 L_kc1
L_kc2:
    s_waitcnt vmcnt(16)
    v_mfma_f32_16x16x32_bf16 v[44:47], v[84:87], v[20:23], 0
    buffer_load_dwordx4 v[84:87], v5, s[16:19], s47 offen offset:0 nt
    s_waitcnt vmcnt(16)
    v_mfma_f32_16x16x32_bf16 v[44:47], v[88:91], v[24:27], v[44:47]
    buffer_load_dwordx4 v[88:91], v5, s[16:19], s47 offen offset:128 nt
    s_waitcnt vmcnt(16)
    v_mfma_f32_16x16x32_bf16 v[44:47], v[92:95], v[28:31], v[44:47]
    buffer_load_dwordx4 v[92:95], v5, s[16:19], s47 offen offset:256 nt
    s_add_u32 s86, s86, 4
    s_cmp_ge_u32 s86, 63
    s_cselect_b32 s3, 63, 0
    s_cselect_b32 s4, 196608, 0
    s_sub_u32 s86, s86, s3
    s_add_u32 s87, s87, s4
    s_cmp_eq_u32 s87, s18
    s_cselect_b32 s87, 0, s87
    s_mul_i32 s3, s86, 49
    s_lshr_b32 s3, s3, 10
    s_mul_i32 s3, s3, 33408
    s_mul_i32 s47, s86, 1536
    s_add_u32 s3, s3, s87
    s_add_u32 s47, s47, s3
    v_mov_b32_dpp v14, v48 quad_perm:[0,0,0,0] row_mask:0xf bank_mask:0xf
    v_add_f32_dpp v14, v49, v14 quad_perm:[1,1,1,1] row_mask:0xf bank_mask:0xf
    v_add_f32_dpp v14, v50, v14 quad_perm:[2,2,2,2] row_mask:0xf bank_mask:0xf
    v_add_f32_dpp v14, v51, v14 quad_perm:[3,3,3,3] row_mask:0xf bank_mask:0xf
    ds_write_b32 v80, v14 offset:16
    s_waitcnt vmcnt(16)
    v_mfma_f32_16x16x32_bf16 v[48:51], v[96:99], v[20:23], 0
    buffer_load_dwordx4 v[96:99], v5, s[16:19], s47 offen offset:0 nt
    s_waitcnt vmcnt(16)
    v_mfma_f32_16x16x32_bf16 v[48:51], v[100:103], v[24:27], v[48:51]
    buffer_load_dwordx4 v[100:103], v5, s[16:19], s47 offen offset:128 nt
    s_waitcnt vmcnt(16)
    v_mfma_f32_16x16x32_bf16 v[48:51], v[104:107], v[28:31], v[48:51]
    buffer_load_dwordx4 v[104:107], v5, s[16:19], s47 offen offset:256 nt
    s_add_u32 s86, s86, 4
    s_cmp_ge_u32 s86, 63
    s_cselect_b32 s3, 63, 0
    s_cselect_b32 s4, 196608, 0
    s_sub_u32 s86, s86, s3
    s_add_u32 s87, s87, s4
    s_cmp_eq_u32 s87, s18
    s_cselect_b32 s87, 0, s87
    s_mul_i32 s3, s86, 49
    s_lshr_b32 s3, s3, 10
    s_mul_i32 s3, s3, 33408
    s_mul_i32 s47, s86, 1536
    s_add_u32 s3, s3, s87
    s_add_u32 s47, s47, s3
    v_mov_b32_dpp v14, v44 quad_perm:[0,0,0,0] row_mask:0xf bank_mask:0xf
    v_add_f32_dpp v14, v45, v14 quad_perm:[1,1,1,1] row_mask:0xf bank_mask:0xf
    v_add_f32_dpp v14, v46, v14 quad_perm:[2,2,2,2] row_mask:0xf bank_mask:0xf
    v_add_f32_dpp v14, v47, v14 quad_perm:[3,3,3,3] row_mask:0xf bank_mask:0xf
    ds_write_b32 v80, v14 offset:20
    s_waitcnt vmcnt(16)
    v_mfma_f32_16x16x32_bf16 v[44:47], v[108:111], v[20:23], 0
    buffer_load_dwordx4 v[108:111], v5, s[16:19], s47 offen offset:0 nt
    s_waitcnt vmcnt(16)
    v_mfma_f32_16x16x32_bf16 v[44:47], v[112:115], v[24:27], v[44:47]
    buffer_load_dwordx4 v[112:115], v5, s[16:19], s47 offen offset:128 nt
    s_waitcnt vmcnt(16)
    v_mfma_f32_16x16x32_bf16 v[44:47], v[116:119], v[28:31], v[44:47]
    buffer_load_dwordx4 v[116:119], v5, s[16:19], s47 offen offset:256 nt
    s_add_u32 s86, s86, 4
    s_cmp_ge_u32 s86, 63
    s_cselect_b32 s3, 63, 0
    s_cselect_b32 s4, 196608, 0
    s_sub_u32 s86, s86, s3
    s_add_u32 s87, s87, s4
    s_cmp_eq_u32 s87, s18
    s_cselect_b32 s87, 0, s87
    s_mul_i32 s3, s86, 49
    s_lshr_b32 s3, s3, 10
    s_mul_i32 s3, s3, 33408
    s_mul_i32 s47, s86, 1536
    s_add_u32 s3, s3, s87
    s_add_u32 s47, s47, s3
    v_mov_b32_dpp v14, v48 quad_perm:[0,0,0,0] row_mask:0xf bank_mask:0xf
    v_add_f32_dpp v14, v49, v14 quad_perm:[1,1,1,1] row_mask:0xf bank_mask:0xf
    v_add_f32_dpp v14, v50, v14 quad_perm:[2,2,2,2] row_mask:0xf bank_mask:0xf
    v_add_f32_dpp v14, v51, v14 quad_perm:[3,3,3,3] row_mask:0xf bank_mask:0xf
    ds_write_b32 v80, v14 offset:24
    s_waitcnt vmcnt(16)
    v_mfma_f32_16x16x32_bf16 v[48:51], v[120:123], v[20:23], 0
    buffer_load_dwordx4 v[120:123], v5, s[16:19], s47 offen offset:0 nt
    s_waitcnt vmcnt(16)
    v_mfma_f32_16x16x32_bf16 v[48:51], v[124:127], v[24:27], v[48:51]
    buffer_load_dwordx4 v[124:127], v5, s[16:19], s47 offen offset:128 nt
    s_waitcnt vmcnt(16)
    v_mfma_f32_16x16x32_bf16 v[48:51], v[128:131], v[28:31], v[48:51]
    buffer_load_dwordx4 v[128:131], v5, s[16:19], s47 offen offset:256 nt
    s_add_u32 s86, s86, 4
    s_cmp_ge_u32 s86, 63
    s_cselect_b32 s3, 63, 0
    s_cselect_b32 s4, 196608, 0
    s_sub_u32 s86, s86, s3
    s_add_u32 s87, s87, s4
    s_cmp_eq_u32 s87, s18
    s_cselect_b32 s87, 0, s87
    s_mul_i32 s3, s86, 49
    s_lshr_b32 s3, s3, 10
    s_mul_i32 s3, s3, 33408
    s_mul_i32 s47, s86, 1536
    s_add_u32 s3, s3, s87
    s_add_u32 s47, s47, s3
    v_mov_b32_dpp v14, v44 quad_perm:[0,0,0,0] row_mask:0xf bank_mask:0xf
    v_add_f32_dpp v14, v45, v14 quad_perm:[1,1,1,1] row_mask:0xf bank_mask:0xf
    v_add_f32_dpp v14, v46, v14 quad_perm:[2,2,2,2] row_mask:0xf bank_mask:0xf
    v_add_f32_dpp v14, v47, v14 quad_perm:[3,3,3,3] row_mask:0xf bank_mask:0xf
    ds_write_b32 v80, v14 offset:28
    v_add_u32 v80, 36, v80
    s_setpc_b64 s[58:59]
L_kc1:
    s_waitcnt vmcnt(10)
    v_mfma_f32_16x16x32_bf16 v[44:47], v[84:87], v[20:23], 0
    buffer_load_dwordx4 v[84:87], v5, s[16:19], s47 offen offset:0 nt
    s_waitcnt vmcnt(10)
    v_mfma_f32_16x16x32_bf16 v[44:47], v[88:91], v[24:27], v[44:47]
    buffer_load_dwordx4 v[88:91], v5, s[16:19], s47 offen offset:128 nt
    s_waitcnt vmcnt(10)
    v_mfma_f32_16x16x32_bf16 v[44:47], v[92:95], v[28:31], v[44:47]
    buffer_load_dwordx4 v[92:95], v5, s[16:19], s47 offen offset:256 nt
    s_add_u32 s86, s86, 4
    s_cmp_ge_u32 s86, 63
    s_cselect_b32 s3, 63, 0
    s_cselect_b32 s4, 196608, 0
    s_sub_u32 s86, s86, s3
    s_add_u32 s87, s87, s4
    s_cmp_eq_u32 s87, s18
    s_cselect_b32 s87, 0, s87
    s_mul_i32 s3, s86, 49
    s_lshr_b32 s3, s3, 10
    s_mul_i32 s3, s3, 33408
    s_mul_i32 s47, s86, 1536
    s_add_u32 s3, s3, s87
    s_add_u32 s47, s47, s3
    v_mov_b32_dpp v14, v48 quad_perm:[0,0,0,0] row_mask:0xf bank_mask:0xf
    v_add_f32_dpp v14, v49, v14 quad_perm:[1,1,1,1] row_mask:0xf bank_mask:0xf
    v_add_f32_dpp v14, v50, v14 quad_perm:[2,2,2,2] row_mask:0xf bank_mask:0xf
    v_add_f32_dpp v14, v51, v14 quad_perm:[3,3,3,3] row_mask:0xf bank_mask:0xf
    ds_write_b32 v80, v14 offset:16
    s_waitcnt vmcnt(10)
    v_mfma_f32_16x16x32_bf16 v[48:51], v[96:99], v[20:23], 0
    buffer_load_dwordx4 v[96:99], v5, s[16:19], s47 offen offset:0 nt
    s_waitcnt vmcnt(10)
    v_mfma_f32_16x16x32_bf16 v[48:51], v[100:103], v[24:27], v[48:51]
    buffer_load_dwordx4 v[100:103], v5, s[16:19], s47 offen offset:128 nt
    s_waitcnt vmcnt(10)
    v_mfma_f32_16x16x32_bf16 v[48:51], v[104:107], v[28:31], v[48:51]
    buffer_load_dwordx4 v[104:107], v5, s[16:19], s47 offen offset:256 nt
    s_add_u32 s86, s86, 4
    s_cmp_ge_u32 s86, 63
    s_cselect_b32 s3, 63, 0
    s_cselect_b32 s4, 196608, 0
    s_sub_u32 s86, s86, s3
    s_add_u32 s87, s87, s4
    s_cmp_eq_u32 s87, s18
    s_cselect_b32 s87, 0, s87
    s_mul_i32 s3, s86, 49
    s_lshr_b32 s3, s3, 10
    s_mul_i32 s3, s3, 33408
    s_mul_i32 s47, s86, 1536
    s_add_u32 s3, s3, s87
    s_add_u32 s47, s47, s3
    v_mov_b32_dpp v14, v44 quad_perm:[0,0,0,0] row_mask:0xf bank_mask:0xf
    v_add_f32_dpp v14, v45, v14 quad_perm:[1,1,1,1] row_mask:0xf bank_mask:0xf
    v_add_f32_dpp v14, v46, v14 quad_perm:[2,2,2,2] row_mask:0xf bank_mask:0xf
    v_add_f32_dpp v14, v47, v14 quad_perm:[3,3,3,3] row_mask:0xf bank_mask:0xf
    ds_write_b32 v80, v14 offset:20
    s_waitcnt vmcnt(5)
    v_mfma_f32_16x16x32_bf16 v[44:47], v[108:111], v[20:23], 0
    buffer_load_dwordx4 v[108:111], v5, s[16:19], s47 offen offset:0 nt
    s_waitcnt vmcnt(5)
    v_mfma_f32_16x16x32_bf16 v[44:47], v[112:115], v[24:27], v[44:47]
    buffer_load_dwordx4 v[112:115], v5, s[16:19], s47 offen offset:128 nt
    s_waitcnt vmcnt(5)
    v_mfma_f32_16x16x32_bf16 v[44:47], v[116:119], v[28:31], v[44:47]
    buffer_load_dwordx4 v[116:119], v5, s[16:19], s47 offen offset:256 nt
    s_add_u32 s86, s86, 4
    s_cmp_ge_u32 s86, 63
    s_cselect_b32 s3, 63, 0
    s_cselect_b32 s4, 196608, 0
    s_sub_u32 s86, s86, s3
    s_add_u32 s87, s87, s4
    s_cmp_eq_u32 s87, s18
    s_cselect_b32 s87, 0, s87
    s_mul_i32 s3, s86, 49
    s_lshr_b32 s3, s3, 10
    s_mul_i32 s3, s3, 33408
    s_mul_i32 s47, s86, 1536
    s_add_u32 s3, s3, s87
    s_add_u32 s47, s47, s3
    v_mov_b32_dpp v14, v48 quad_perm:[0,0,0,0] row_mask:0xf bank_mask:0xf
    v_add_f32_dpp v14, v49, v14 quad_perm:[1,1,1,1] row_mask:0xf bank_mask:0xf
    v_add_f32_dpp v14, v50, v14 quad_perm:[2,2,2,2] row_mask:0xf bank_mask:0xf
    v_add_f32_dpp v14, v51, v14 quad_perm:[3,3,3,3] row_mask:0xf bank_mask:0xf
    ds_write_b32 v80, v14 offset:24
    s_waitcnt vmcnt(5)
    v_mfma_f32_16x16x32_bf16 v[48:51], v[120:123], v[20:23], 0
    buffer_load_dwordx4 v[120:123], v5, s[16:19], s47 offen offset:0 nt
    s_waitcnt vmcnt(5)
    v_mfma_f32_16x16x32_bf16 v[48:51], v[124:127], v[24:27], v[48:51]
    buffer_load_dwordx4 v[124:127], v5, s[16:19], s47 offen offset:128 nt
    s_waitcnt vmcnt(5)
    v_mfma_f32_16x16x32_bf16 v[48:51], v[128:131], v[28:31], v[48:51]
    buffer_load_dwordx4 v[128:131], v5, s[16:19], s47 offen offset:256 nt
    s_add_u32 s86, s86, 4
    s_cmp_ge_u32 s86, 63
    s_cselect_b32 s3, 63, 0
    s_cselect_b32 s4, 196608, 0
    s_sub_u32 s86, s86, s3
    s_add_u32 s87, s87, s4
    s_cmp_eq_u32 s87, s18
    s_cselect_b32 s87, 0, s87
    s_mul_i32 s3, s86, 49
    s_lshr_b32 s3, s3, 10
    s_mul_i32 s3, s3, 33408
    s_mul_i32 s47, s86, 1536
    s_add_u32 s3, s3, s87
    s_add_u32 s47, s47, s3
    v_mov_b32_dpp v14, v44 quad_perm:[0,0,0,0] row_mask:0xf bank_mask:0xf
    v_add_f32_dpp v14, v45, v14 quad_perm:[1,1,1,1] row_mask:0xf bank_mask:0xf
    v_add_f32_dpp v14, v46, v14 quad_perm:[2,2,2,2] row_mask:0xf bank_mask:0xf
    v_add_f32_dpp v14, v47, v14 quad_perm:[3,3,3,3] row_mask:0xf bank_mask:0xf
    ds_write_b32 v80, v14 offset:28
    v_add_u32 v80, 36, v80
    s_setpc_b64 s[58:59]
L_kc0:
    s_waitcnt vmcnt(9)
    v_mfma_f32_16x16x32_bf16 v[44:47], v[84:87], v[20:23], 0
    buffer_load_dwordx4 v[84:87], v5, s[16:19], s47 offen offset:0 nt
    s_waitcnt vmcnt(9)
    v_mfma_f32_16x16x32_bf16 v[44:47], v[88:91], v[24:27], v[44:47]
    buffer_load_dwordx4 v[88:91], v5, s[16:19], s47 offen offset:128 nt
    s_waitcnt vmcnt(9)
    v_mfma_f32_16x16x32_bf16 v[44:47], v[92:95], v[28:31], v[44:47]
    buffer_load_dwordx4 v[92:95], v5, s[16:19], s47 offen offset:256 nt
    s_add_u32 s86, s86, 4
    s_cmp_ge_u32 s86, 63
    s_cselect_b32 s3, 63, 0
    s_cselect_b32 s4, 196608, 0
    s_sub_u32 s86, s86, s3
    s_add_u32 s87, s87, s4
    s_cmp_eq_u32 s87, s18
    s_cselect_b32 s87, 0, s87
    s_mul_i32 s3, s86, 49
    s_lshr_b32 s3, s3, 10
    s_mul_i32 s3, s3, 33408
    s_mul_i32 s47, s86, 1536
    s_add_u32 s3, s3, s87
    s_add_u32 s47, s47, s3
    v_mov_b32_dpp v14, v48 quad_perm:[0,0,0,0] row_mask:0xf bank_mask:0xf
    v_add_f32_dpp v14, v49, v14 quad_perm:[1,1,1,1] row_mask:0xf bank_mask:0xf
    v_add_f32_dpp v14, v50, v14 quad_perm:[2,2,2,2] row_mask:0xf bank_mask:0xf
    v_add_f32_dpp v14, v51, v14 quad_perm:[3,3,3,3] row_mask:0xf bank_mask:0xf
    ds_write_b32 v80, v14 offset:16
    s_waitcnt vmcnt(9)
    v_mfma_f32_16x16x32_bf16 v[48:51], v[96:99], v[20:23], 0
    buffer_load_dwordx4 v[96:99], v5, s[16:19], s47 offen offset:0 nt
    s_waitcnt vmcnt(9)
    v_mfma_f32_16x16x32_bf16 v[48:51], v[100:103], v[24:27], v[48:51]
    buffer_load_dwordx4 v[100:103], v5, s[16:19], s47 offen offset:128 nt
    s_waitcnt vmcnt(4)
    v_mfma_f32_16x16x32_bf16 v[48:51], v[104:107], v[28:31], v[48:51]
    buffer_load_dwordx4 v[104:107], v5, s[16:19], s47 offen offset:256 nt
    s_add_u32 s86, s86, 4
    s_cmp_ge_u32 s86, 63
    s_cselect_b32 s3, 63, 0
    s_cselect_b32 s4, 196608, 0
    s_sub_u32 s86, s86, s3
    s_add_u32 s87, s87, s4
    s_cmp_eq_u32 s87, s18
    s_cselect_b32 s87, 0, s87
    s_mul_i32 s3, s86, 49
    s_lshr_b32 s3, s3, 10
    s_mul_i32 s3, s3, 33408
    s_mul_i32 s47, s86, 1536
    s_add_u32 s3, s3, s87
    s_add_u32 s47, s47, s3
    v_mov_b32_dpp v14, v44 quad_perm:[0,0,0,0] row_mask:0xf bank_mask:0xf
    v_add_f32_dpp v14, v45, v14 quad_perm:[1,1,1,1] row_mask:0xf bank_mask:0xf
    v_add_f32_dpp v14, v46, v14 quad_perm:[2,2,2,2] row_mask:0xf bank_mask:0xf
    v_add_f32_dpp v14, v47, v14 quad_perm:[3,3,3,3] row_mask:0xf bank_mask:0xf
    ds_write_b32 v80, v14 offset:20
    s_waitcnt vmcnt(4)
    v_mfma_f32_16x16x32_bf16 v[44:47], v[108:111], v[20:23], 0
    buffer_load_dwordx4 v[108:111], v5, s[16:19], s47 offen offset:0 nt
    s_waitcnt vmcnt(4)
    v_mfma_f32_16x16x32_bf16 v[44:47], v[112:115], v[24:27], v[44:47]
    buffer_load_dwordx4 v[112:115], v5, s[16:19], s47 offen offset:128 nt
    s_waitcnt vmcnt(4)
    v_mfma_f32_16x16x32_bf16 v[44:47], v[116:119], v[28:31], v[44:47]
    buffer_load_dwordx4 v[116:119], v5, s[16:19], s47 offen offset:256 nt
    s_add_u32 s86, s86, 4
    s_cmp_ge_u32 s86, 63
    s_cselect_b32 s3, 63, 0
    s_cselect_b32 s4, 196608, 0
    s_sub_u32 s86, s86, s3
    s_add_u32 s87, s87, s4
    s_cmp_eq_u32 s87, s18
    s_cselect_b32 s87, 0, s87
    s_mul_i32 s3, s86, 49
    s_lshr_b32 s3, s3, 10
    s_mul_i32 s3, s3, 33408
    s_mul_i32 s47, s86, 1536
    s_add_u32 s3, s3, s87
    s_add_u32 s47, s47, s3
    v_mov_b32_dpp v14, v48 quad_perm:[0,0,0,0] row_mask:0xf bank_mask:0xf
    v_add_f32_dpp v14, v49, v14 quad_perm:[1,1,1,1] row_mask:0xf bank_mask:0xf
    v_add_f32_dpp v14, v50, v14 quad_perm:[2,2,2,2] row_mask:0xf bank_mask:0xf
    v_add_f32_dpp v14, v51, v14 quad_perm:[3,3,3,3] row_mask:0xf bank_mask:0xf
    ds_write_b32 v80, v14 offset:24
    s_waitcnt vmcnt(4)
    v_mfma_f32_16x16x32_bf16 v[48:51], v[120:123], v[20:23], 0
    buffer_load_dwordx4 v[120:123], v5, s[16:19], s47 offen offset:0 nt
    s_waitcnt vmcnt(4)
    v_mfma_f32_16x16x32_bf16 v[48:51], v[124:127], v[24:27], v[48:51]
    buffer_load_dwordx4 v[124:127], v5, s[16:19], s47 offen offset:128 nt
    s_waitcnt vmcnt(4)
    v_mfma_f32_16x16x32_bf16 v[48:51], v[128:131], v[28:31], v[48:51]
    buffer_load_dwordx4 v[128:131], v5, s[16:19], s47 offen offset:256 nt
    s_add_u32 s86, s86, 4
    s_cmp_ge_u32 s86, 63
    s_cselect_b32 s3, 63, 0
    s_cselect_b32 s4, 196608, 0
    s_sub_u32 s86, s86, s3
    s_add_u32 s87, s87, s4
    s_cmp_eq_u32 s87, s18
    s_cselect_b32 s87, 0, s87
    s_mul_i32 s3, s86, 49
    s_lshr_b32 s3, s3, 10
    s_mul_i32 s3, s3, 33408
    s_mul_i32 s47, s86, 1536
    s_add_u32 s3, s3, s87
    s_add_u32 s47, s47, s3
    v_mov_b32_dpp v14, v44 quad_perm:[0,0,0,0] row_mask:0xf bank_mask:0xf
    v_add_f32_dpp v14, v45, v14 quad_perm:[1,1,1,1] row_mask:0xf bank_mask:0xf
    v_add_f32_dpp v14, v46, v14 quad_perm:[2,2,2,2] row_mask:0xf bank_mask:0xf
    v_add_f32_dpp v14, v47, v14 quad_perm:[3,3,3,3] row_mask:0xf bank_mask:0xf
    ds_write_b32 v80, v14 offset:28
    v_add_u32 v80, 36, v80
    s_setpc_b64 s[58:59]
L_vblock:
    s_barrier
    s_memrealtime s[4:5]
    s_waitcnt lgkmcnt(0)
    s_call_b64 s[84:85], L_anchor
    s_sub_u32 s4, s4, s80
    s_add_u32 s80, s80, s82
    s_cmp_lt_i32 s4, -50
    s_cbranch_scc1 L_vb0
    s_cmp_lt_i32 s4, 50
    s_cbranch_scc1 L_vb1
L_vb2:
    s_waitcnt vmcnt(11)
    v_mfma_f32_16x16x32_bf16 v[32:35], v[52:55], v[84:87], v[32:35]
    buffer_load_dwordx4 v[84:87], v6, s[20:23], s47 offen offset:0 nt
    s_waitcnt vmcnt(11)
    v_mfma_f32_16x16x32_bf16 v[36:39], v[52:55], v[88:91], v[36:39]
    buffer_load_dwordx4 v[88:91], v6, s[20:23], s47 offen offset:128 nt
    s_waitcnt vmcnt(11)
    v_mfma_f32_16x16x32_bf16 v[40:43], v[52:55], v[92:95], v[40:43]
    buffer_load_dwordx4 v[92:95], v6, s[20:23], s47 offen offset:256 nt
    s_add_u32 s86, s86, 4
    s_cmp_ge_u32 s86, 63
    s_cselect_b32 s3, 63, 0
    s_cselect_b32 s4, 196608, 0
    s_sub_u32 s86, s86, s3
    s_add_u32 s87, s87, s4
    s_cmp_eq_u32 s87, s18
    s_cselect_b32 s87, 0, s87
    s_mul_i32 s3, s86, 49
    s_lshr_b32 s3, s3, 10
    s_mul_i32 s3, s3, 33408
    s_mul_i32 s47, s86, 1536
    s_add_u32 s3, s3, s87
    s_add_u32 s47, s47, s3
    v_and_b32 v56, v61, v16
    v_and_b32 v57, v61, v17
    v_and_b32 v58, v61, v18
    v_and_b32 v59, v61, v19
    s_nop 0
    s_waitcnt vmcnt(11)
    v_mfma_f32_16x16x32_bf16 v[32:35], v[56:59], v[96:99], v[32:35]
    buffer_load_dwordx4 v[96:99], v6, s[20:23], s47 offen offset:0 nt
    s_waitcnt vmcnt(11)
    v_mfma_f32_16x16x32_bf16 v[36:39], v[56:59], v[100:103], v[36:39]
    buffer_load_dwordx4 v[100:103], v6, s[20:23], s47 offen offset:128 nt
    s_waitcnt vmcnt(11)
    v_mfma_f32_16x16x32_bf16 v[40:43], v[56:59], v[104:107], v[40:43]
    buffer_load_dwordx4 v[104:107], v6, s[20:23], s47 offen offset:256 nt
    s_add_u32 s86, s86, 4
    s_cmp_ge_u32 s86, 63
    s_cselect_b32 s3, 63, 0
    s_cselect_b32 s4, 196608, 0
    s_sub_u32 s86, s86, s3
    s_add_u32 s87, s87, s4
    s_cmp_eq_u32 s87, s18
    s_cselect_b32 s87, 0, s87
    s_mul_i32 s3, s86, 49
    s_lshr_b32 s3, s3, 10
    s_mul_i32 s3, s3, 33408
    s_mul_i32 s47, s86, 1536
    s_add_u32 s3, s3, s87
    s_add_u32 s47, s47, s3
    v_and_b32 v52, v62, v16
    v_and_b32 v53, v62, v17
    v_and_b32 v54, v62, v18
    v_and_b32 v55, v62, v19
    s_nop 0
    s_waitcnt vmcnt(11)
    v_mfma_f32_16x16x32_bf16 v[32:35], v[52:55], v[108:111], v[32:35]
    buffer_load_dwordx4 v[108:111], v6, s[20:23], s47 offen offset:0 nt
    s_waitcnt vmcnt(11)
    v_mfma_f32_16x16x32_bf16 v[36:39], v[52:55], v[112:115], v[36:39]
    buffer_load_dwordx4 v[112:115], v6, s[20:23], s47 offen offset:128 nt
    s_waitcnt vmcnt(11)
    v_mfma_f32_16x16x32_bf16 v[40:43], v[52:55], v[116:119], v[40:43]
    buffer_load_dwordx4 v[116:119], v6, s[20:23], s47 offen offset:256 nt
    s_add_u32 s86, s86, 4
    s_cmp_ge_u32 s86, 63
    s_cselect_b32 s3, 63, 0
    s_cselect_b32 s4, 196608, 0
    s_sub_u32 s86, s86, s3
    s_add_u32 s87, s87, s4
    s_cmp_eq_u32 s87, s18
    s_cselect_b32 s87, 0, s87
    s_mul_i32 s3, s86, 49
    s_lshr_b32 s3, s3, 10
    s_mul_i32 s3, s3, 33408
    s_mul_i32 s47, s86, 1536
    s_add_u32 s3, s3, s87
    s_add_u32 s47, s47, s3
    v_and_b32 v56, v63, v16
    v_and_b32 v57, v63, v17
    v_and_b32 v58, v63, v18
    v_and_b32 v59, v63, v19
    s_nop 0
    s_waitcnt vmcnt(11)
    v_mfma_f32_16x16x32_bf16 v[32:35], v[56:59], v[120:123], v[32:35]
    buffer_load_dwordx4 v[120:123], v6, s[20:23], s47 offen offset:0 nt
    s_waitcnt vmcnt(11)
    v_mfma_f32_16x16x32_bf16 v[36:39], v[56:59], v[124:127], v[36:39]
    buffer_load_dwordx4 v[124:127], v6, s[20:23], s47 offen offset:128 nt
    s_waitcnt vmcnt(11)
    v_mfma_f32_16x16x32_bf16 v[40:43], v[56:59], v[128:131], v[40:43]
    buffer_load_dwordx4 v[128:131], v6, s[20:23], s47 offen offset:256 nt
    s_add_u32 s86, s86, 4
    s_cmp_ge_u32 s86, 63
    s_cselect_b32 s3, 63, 0
    s_cselect_b32 s4, 196608, 0
    s_sub_u32 s86, s86, s3
    s_add_u32 s87, s87, s4
    s_cmp_eq_u32 s87, s18
    s_cselect_b32 s87, 0, s87
    s_mul_i32 s3, s86, 49
    s_lshr_b32 s3, s3, 10
    s_mul_i32 s3, s3, 33408
    s_mul_i32 s47, s86, 1536
    s_add_u32 s3, s3, s87
    s_add_u32 s47, s47, s3
    s_waitcnt lgkmcnt(0)
    v_and_b32 v52, v64, v16
    v_and_b32 v53, v64, v17
    v_and_b32 v54, v64, v18
    v_and_b32 v55, v64, v19
    ds_read_b128 v[60:63], v81 offset:32
    s_waitcnt vmcnt(11)
    v_mfma_f32_16x16x32_bf16 v[32:35], v[52:55], v[84:87], v[32:35]
    buffer_load_dwordx4 v[84:87], v6, s[20:23], s47 offen offset:0 nt
    s_waitcnt vmcnt(11)
    v_mfma_f32_16x16x32_bf16 v[36:39], v[52:55], v[88:91], v[36:39]
    buffer_load_dwordx4 v[88:91], v6, s[20:23], s47 offen offset:128 nt
    s_waitcnt vmcnt(11)
    v_mfma_f32_16x16x32_bf16 v[40:43], v[52:55], v[92:95], v[40:43]
    buffer_load_dwordx4 v[92:95], v6, s[20:23], s47 offen offset:256 nt
    s_add_u32 s86, s86, 4
    s_cmp_ge_u32 s86, 63
    s_cselect_b32 s3, 63, 0
    s_cselect_b32 s4, 196608, 0
    s_sub_u32 s86, s86, s3
    s_add_u32 s87, s87, s4
    s_cmp_eq_u32 s87, s18
    s_cselect_b32 s87, 0, s87
    s_mul_i32 s3, s86, 49
    s_lshr_b32 s3, s3, 10
    s_mul_i32 s3, s3, 33408
    s_mul_i32 s47, s86, 1536
    s_add_u32 s3, s3, s87
    s_add_u32 s47, s47, s3
    v_and_b32 v56, v65, v16
    v_and_b32 v57, v65, v17
    v_and_b32 v58, v65, v18
    v_and_b32 v59, v65, v19
    s_nop 0
    s_waitcnt vmcnt(11)
    v_mfma_f32_16x16x32_bf16 v[32:35], v[56:59], v[96:99], v[32:35]
    buffer_load_dwordx4 v[96:99], v6, s[20:23], s47 offen offset:0 nt
    s_waitcnt vmcnt(11)
    v_mfma_f32_16x16x32_bf16 v[36:39], v[56:59], v[100:103], v[36:39]
    buffer_load_dwordx4 v[100:103], v6, s[20:23], s47 offen offset:128 nt
    s_waitcnt vmcnt(11)
    v_mfma_f32_16x16x32_bf16 v[40:43], v[56:59], v[104:107], v[40:43]
    buffer_load_dwordx4 v[104:107], v6, s[20:23], s47 offen offset:256 nt
    s_add_u32 s86, s86, 4
    s_cmp_ge_u32 s86, 63
    s_cselect_b32 s3, 63, 0
    s_cselect_b32 s4, 196608, 0
    s_sub_u32 s86, s86, s3
    s_add_u32 s87, s87, s4
    s_cmp_eq_u32 s87, s18
    s_cselect_b32 s87, 0, s87
    s_mul_i32 s3, s86, 49
    s_lshr_b32 s3, s3, 10
    s_mul_i32 s3, s3, 33408
    s_mul_i32 s47, s86, 1536
    s_add_u32 s3, s3, s87
    s_add_u32 s47, s47, s3
    v_and_b32 v52, v66, v16
    v_and_b32 v53, v66, v17
    v_and_b32 v54, v66, v18
    v_and_b32 v55, v66, v19
    s_nop 0
    s_waitcnt vmcnt(11)
    v_mfma_f32_16x16x32_bf16 v[32:35], v[52:55], v[108:111], v[32:35]
    buffer_load_dwordx4 v[108:111], v6, s[20:23], s47 offen offset:0 nt
    s_waitcnt vmcnt(11)
    v_mfma_f32_16x16x32_bf16 v[36:39], v[52:55], v[112:115], v[36:39]
    buffer_load_dwordx4 v[112:115], v6, s[20:23], s47 offen offset:128 nt
    s_waitcnt vmcnt(11)
    v_mfma_f32_16x16x32_bf16 v[40:43], v[52:55], v[116:119], v[40:43]
    buffer_load_dwordx4 v[116:119], v6, s[20:23], s47 offen offset:256 nt
    s_add_u32 s86, s86, 4
    s_cmp_ge_u32 s86, 63
    s_cselect_b32 s3, 63, 0
    s_cselect_b32 s4, 196608, 0
    s_sub_u32 s86, s86, s3
    s_add_u32 s87, s87, s4
    s_cmp_eq_u32 s87, s18
    s_cselect_b32 s87, 0, s87
    s_mul_i32 s3, s86, 49
    s_lshr_b32 s3, s3, 10
    s_mul_i32 s3, s3, 33408
    s_mul_i32 s47, s86, 1536
    s_add_u32 s3, s3, s87
    s_add_u32 s47, s47, s3
    v_and_b32 v56, v67, v16
    v_and_b32 v57, v67, v17
    v_and_b32 v58, v67, v18
    v_and_b32 v59, v67, v19
    s_nop 0
    s_waitcnt vmcnt(11)
    v_mfma_f32_16x16x32_bf16 v[32:35], v[56:59], v[120:123], v[32:35]
    buffer_load_dwordx4 v[120:123], v6, s[20:23], s47 offen offset:0 nt
    s_waitcnt vmcnt(11)
    v_mfma_f32_16x16x32_bf16 v[36:39], v[56:59], v[124:127], v[36:39]
    buffer_load_dwordx4 v[124:127], v6, s[20:23], s47 offen offset:128 nt
    s_waitcnt vmcnt(11)
    v_mfma_f32_16x16x32_bf16 v[40:43], v[56:59], v[128:131], v[40:43]
    buffer_load_dwordx4 v[128:131], v6, s[20:23], s47 offen offset:256 nt
    s_add_u32 s86, s86, 4
    s_cmp_ge_u32 s86, 63
    s_cselect_b32 s3, 63, 0
    s_cselect_b32 s4, 196608, 0
    s_sub_u32 s86, s86, s3
    s_add_u32 s87, s87, s4
    s_cmp_eq_u32 s87, s18
    s_cselect_b32 s87, 0, s87
    s_mul_i32 s3, s86, 49
    s_lshr_b32 s3, s3, 10
    s_mul_i32 s3, s3, 33408
    s_mul_i32 s47, s86, 1536
    s_add_u32 s3, s3, s87
    s_add_u32 s47, s47, s3
    s_waitcnt lgkmcnt(0)
    v_and_b32 v52, v60, v16
    v_and_b32 v53, v60, v17
    v_and_b32 v54, v60, v18
    v_and_b32 v55, v60, v19
    ds_read_b128 v[64:67], v81 offset:48
    v_add_u32 v81, 32, v81
    s_setpc_b64 s[58:59]
L_vb1:
    s_waitcnt vmcnt(5)
    v_mfma_f32_16x16x32_bf16 v[32:35], v[52:55], v[84:87], v[32:35]
    buffer_load_dwordx4 v[84:87], v6, s[20:23], s47 offen offset:0 nt
    s_waitcnt vmcnt(5)
    v_mfma_f32_16x16x32_bf16 v[36:39], v[52:55], v[88:91], v[36:39]
    buffer_load_dwordx4 v[88:91], v6, s[20:23], s47 offen offset:128 nt
    s_waitcnt vmcnt(5)
    v_mfma_f32_16x16x32_bf16 v[40:43], v[52:55], v[92:95], v[40:43]
    buffer_load_dwordx4 v[92:95], v6, s[20:23], s47 offen offset:256 nt
    s_add_u32 s86, s86, 4
    s_cmp_ge_u32 s86, 63
    s_cselect_b32 s3, 63, 0
    s_cselect_b32 s4, 196608, 0
    s_sub_u32 s86, s86, s3
    s_add_u32 s87, s87, s4
    s_cmp_eq_u32 s87, s18
    s_cselect_b32 s87, 0, s87
    s_mul_i32 s3, s86, 49
    s_lshr_b32 s3, s3, 10
    s_mul_i32 s3, s3, 33408
    s_mul_i32 s47, s86, 1536
    s_add_u32 s3, s3, s87
    s_add_u32 s47, s47, s3
    v_and_b32 v56, v61, v16
    v_and_b32 v57, v61, v17
    v_and_b32 v58, v61, v18
    v_and_b32 v59, v61, v19
    s_nop 0
    s_waitcnt vmcnt(5)
    v_mfma_f32_16x16x32_bf16 v[32:35], v[56:59], v[96:99], v[32:35]
    buffer_load_dwordx4 v[96:99], v6, s[20:23], s47 offen offset:0 nt
    s_waitcnt vmcnt(5)
    v_mfma_f32_16x16x32_bf16 v[36:39], v[56:59], v[100:103], v[36:39]
    buffer_load_dwordx4 v[100:103], v6, s[20:23], s47 offen offset:128 nt
    s_waitcnt vmcnt(5)
    v_mfma_f32_16x16x32_bf16 v[40:43], v[56:59], v[104:107], v[40:43]
    buffer_load_dwordx4 v[104:107], v6, s[20:23], s47 offen offset:256 nt
    s_add_u32 s86, s86, 4
    s_cmp_ge_u32 s86, 63
    s_cselect_b32 s3, 63, 0
    s_cselect_b32 s4, 196608, 0
    s_sub_u32 s86, s86, s3
    s_add_u32 s87, s87, s4
    s_cmp_eq_u32 s87, s18
    s_cselect_b32 s87, 0, s87
    s_mul_i32 s3, s86, 49
    s_lshr_b32 s3, s3, 10
    s_mul_i32 s3, s3, 33408
    s_mul_i32 s47, s86, 1536
    s_add_u32 s3, s3, s87
    s_add_u32 s47, s47, s3
    v_and_b32 v52, v62, v16
    v_and_b32 v53, v62, v17
    v_and_b32 v54, v62, v18
    v_and_b32 v55, v62, v19
    s_nop 0
    s_waitcnt vmcnt(5)
    v_mfma_f32_16x16x32_bf16 v[32:35], v[52:55], v[108:111], v[32:35]
    buffer_load_dwordx4 v[108:111], v6, s[20:23], s47 offen offset:0 nt
    s_waitcnt vmcnt(5)
    v_mfma_f32_16x16x32_bf16 v[36:39], v[52:55], v[112:115], v[36:39]
    buffer_load_dwordx4 v[112:115], v6, s[20:23], s47 offen offset:128 nt
    s_waitcnt vmcnt(5)
    v_mfma_f32_16x16x32_bf16 v[40:43], v[52:55], v[116:119], v[40:43]
    buffer_load_dwordx4 v[116:119], v6, s[20:23], s47 offen offset:256 nt
    s_add_u32 s86, s86, 4
    s_cmp_ge_u32 s86, 63
    s_cselect_b32 s3, 63, 0
    s_cselect_b32 s4, 196608, 0
    s_sub_u32 s86, s86, s3
    s_add_u32 s87, s87, s4
    s_cmp_eq_u32 s87, s18
    s_cselect_b32 s87, 0, s87
    s_mul_i32 s3, s86, 49
    s_lshr_b32 s3, s3, 10
    s_mul_i32 s3, s3, 33408
    s_mul_i32 s47, s86, 1536
    s_add_u32 s3, s3, s87
    s_add_u32 s47, s47, s3
    v_and_b32 v56, v63, v16
    v_and_b32 v57, v63, v17
    v_and_b32 v58, v63, v18
    v_and_b32 v59, v63, v19
    s_nop 0
    s_waitcnt vmcnt(5)
    v_mfma_f32_16x16x32_bf16 v[32:35], v[56:59], v[120:123], v[32:35]
    buffer_load_dwordx4 v[120:123], v6, s[20:23], s47 offen offset:0 nt
    s_waitcnt vmcnt(5)
    v_mfma_f32_16x16x32_bf16 v[36:39], v[56:59], v[124:127], v[36:39]
    buffer_load_dwordx4 v[124:127], v6, s[20:23], s47 offen offset:128 nt
    s_waitcnt vmcnt(5)
    v_mfma_f32_16x16x32_bf16 v[40:43], v[56:59], v[128:131], v[40:43]
    buffer_load_dwordx4 v[128:131], v6, s[20:23], s47 offen offset:256 nt
    s_add_u32 s86, s86, 4
    s_cmp_ge_u32 s86, 63
    s_cselect_b32 s3, 63, 0
    s_cselect_b32 s4, 196608, 0
    s_sub_u32 s86, s86, s3
    s_add_u32 s87, s87, s4
    s_cmp_eq_u32 s87, s18
    s_cselect_b32 s87, 0, s87
    s_mul_i32 s3, s86, 49
    s_lshr_b32 s3, s3, 10
    s_mul_i32 s3, s3, 33408
    s_mul_i32 s47, s86, 1536
    s_add_u32 s3, s3, s87
    s_add_u32 s47, s47, s3
    s_waitcnt lgkmcnt(0)
    v_and_b32 v52, v64, v16
    v_and_b32 v53, v64, v17
    v_and_b32 v54, v64, v18
    v_and_b32 v55, v64, v19
    ds_read_b128 v[60:63], v81 offset:32
    s_waitcnt vmcnt(5)
    v_mfma_f32_16x16x32_bf16 v[32:35], v[52:55], v[84:87], v[32:35]
    buffer_load_dwordx4 v[84:87], v6, s[20:23], s47 offen offset:0 nt
    s_waitcnt vmcnt(5)
    v_mfma_f32_16x16x32_bf16 v[36:39], v[52:55], v[88:91], v[36:39]
    buffer_load_dwordx4 v[88:91], v6, s[20:23], s47 offen offset:128 nt
    s_waitcnt vmcnt(5)
    v_mfma_f32_16x16x32_bf16 v[40:43], v[52:55], v[92:95], v[40:43]
    buffer_load_dwordx4 v[92:95], v6, s[20:23], s47 offen offset:256 nt
    s_add_u32 s86, s86, 4
    s_cmp_ge_u32 s86, 63
    s_cselect_b32 s3, 63, 0
    s_cselect_b32 s4, 196608, 0
    s_sub_u32 s86, s86, s3
    s_add_u32 s87, s87, s4
    s_cmp_eq_u32 s87, s18
    s_cselect_b32 s87, 0, s87
    s_mul_i32 s3, s86, 49
    s_lshr_b32 s3, s3, 10
    s_mul_i32 s3, s3, 33408
    s_mul_i32 s47, s86, 1536
    s_add_u32 s3, s3, s87
    s_add_u32 s47, s47, s3
    v_and_b32 v56, v65, v16
    v_and_b32 v57, v65, v17
    v_and_b32 v58, v65, v18
    v_and_b32 v59, v65, v19
    s_nop 0
    s_waitcnt vmcnt(5)
    v_mfma_f32_16x16x32_bf16 v[32:35], v[56:59], v[96:99], v[32:35]
    buffer_load_dwordx4 v[96:99], v6, s[20:23], s47 offen offset:0 nt
    s_waitcnt vmcnt(5)
    v_mfma_f32_16x16x32_bf16 v[36:39], v[56:59], v[100:103], v[36:39]
    buffer_load_dwordx4 v[100:103], v6, s[20:23], s47 offen offset:128 nt
    s_waitcnt vmcnt(5)
    v_mfma_f32_16x16x32_bf16 v[40:43], v[56:59], v[104:107], v[40:43]
    buffer_load_dwordx4 v[104:107], v6, s[20:23], s47 offen offset:256 nt
    s_add_u32 s86, s86, 4
    s_cmp_ge_u32 s86, 63
    s_cselect_b32 s3, 63, 0
    s_cselect_b32 s4, 196608, 0
    s_sub_u32 s86, s86, s3
    s_add_u32 s87, s87, s4
    s_cmp_eq_u32 s87, s18
    s_cselect_b32 s87, 0, s87
    s_mul_i32 s3, s86, 49
    s_lshr_b32 s3, s3, 10
    s_mul_i32 s3, s3, 33408
    s_mul_i32 s47, s86, 1536
    s_add_u32 s3, s3, s87
    s_add_u32 s47, s47, s3
    v_and_b32 v52, v66, v16
    v_and_b32 v53, v66, v17
    v_and_b32 v54, v66, v18
    v_and_b32 v55, v66, v19
    s_nop 0
    s_waitcnt vmcnt(5)
    v_mfma_f32_16x16x32_bf16 v[32:35], v[52:55], v[108:111], v[32:35]
    buffer_load_dwordx4 v[108:111], v6, s[20:23], s47 offen offset:0 nt
    s_waitcnt vmcnt(5)
    v_mfma_f32_16x16x32_bf16 v[36:39], v[52:55], v[112:115], v[36:39]
    buffer_load_dwordx4 v[112:115], v6, s[20:23], s47 offen offset:128 nt
    s_waitcnt vmcnt(5)
    v_mfma_f32_16x16x32_bf16 v[40:43], v[52:55], v[116:119], v[40:43]
    buffer_load_dwordx4 v[116:119], v6, s[20:23], s47 offen offset:256 nt
    s_add_u32 s86, s86, 4
    s_cmp_ge_u32 s86, 63
    s_cselect_b32 s3, 63, 0
    s_cselect_b32 s4, 196608, 0
    s_sub_u32 s86, s86, s3
    s_add_u32 s87, s87, s4
    s_cmp_eq_u32 s87, s18
    s_cselect_b32 s87, 0, s87
    s_mul_i32 s3, s86, 49
    s_lshr_b32 s3, s3, 10
    s_mul_i32 s3, s3, 33408
    s_mul_i32 s47, s86, 1536
    s_add_u32 s3, s3, s87
    s_add_u32 s47, s47, s3
    v_and_b32 v56, v67, v16
    v_and_b32 v57, v67, v17
    v_and_b32 v58, v67, v18
    v_and_b32 v59, v67, v19
    s_nop 0
    s_waitcnt vmcnt(5)
    v_mfma_f32_16x16x32_bf16 v[32:35], v[56:59], v[120:123], v[32:35]
    buffer_load_dwordx4 v[120:123], v6, s[20:23], s47 offen offset:0 nt
    s_waitcnt vmcnt(5)
    v_mfma_f32_16x16x32_bf16 v[36:39], v[56:59], v[124:127], v[36:39]
    buffer_load_dwordx4 v[124:127], v6, s[20:23], s47 offen offset:128 nt
    s_waitcnt vmcnt(5)
    v_mfma_f32_16x16x32_bf16 v[40:43], v[56:59], v[128:131], v[40:43]
    buffer_load_dwordx4 v[128:131], v6, s[20:23], s47 offen offset:256 nt
    s_add_u32 s86, s86, 4
    s_cmp_ge_u32 s86, 63
    s_cselect_b32 s3, 63, 0
    s_cselect_b32 s4, 196608, 0
    s_sub_u32 s86, s86, s3
    s_add_u32 s87, s87, s4
    s_cmp_eq_u32 s87, s18
    s_cselect_b32 s87, 0, s87
    s_mul_i32 s3, s86, 49
    s_lshr_b32 s3, s3, 10
    s_mul_i32 s3, s3, 33408
    s_mul_i32 s47, s86, 1536
    s_add_u32 s3, s3, s87
    s_add_u32 s47, s47, s3
    s_waitcnt lgkmcnt(0)
    v_and_b32 v52, v60, v16
    v_and_b32 v53, v60, v17
    v_and_b32 v54, v60, v18
    v_and_b32 v55, v60, v19
    ds_read_b128 v[64:67], v81 offset:48
    v_add_u32 v81, 32, v81
    s_setpc_b64 s[58:59]
L_vb0:
    s_waitcnt vmcnt(4)
    v_mfma_f32_16x16x32_bf16 v[32:35], v[52:55], v[84:87], v[32:35]
    buffer_load_dwordx4 v[84:87], v6, s[20:23], s47 offen offset:0 nt
    s_waitcnt vmcnt(4)
    v_mfma_f32_16x16x32_bf16 v[36:39], v[52:55], v[88:91], v[36:39]
    buffer_load_dwordx4 v[88:91], v6, s[20:23], s47 offen offset:128 nt
    s_waitcnt vmcnt(4)
    v_mfma_f32_16x16x32_bf16 v[40:43], v[52:55], v[92:95], v[40:43]
    buffer_load_dwordx4 v[92:95], v6, s[20:23], s47 offen offset:256 nt
    s_add_u32 s86, s86, 4
    s_cmp_ge_u32 s86, 63
    s_cselect_b32 s3, 63, 0
    s_cselect_b32 s4, 196608, 0
    s_sub_u32 s86, s86, s3
    s_add_u32 s87, s87, s4
    s_cmp_eq_u32 s87, s18
    s_cselect_b32 s87, 0, s87
    s_mul_i32 s3, s86, 49
    s_lshr_b32 s3, s3, 10
    s_mul_i32 s3, s3, 33408
    s_mul_i32 s47, s86, 1536
    s_add_u32 s3, s3, s87
    s_add_u32 s47, s47, s3
    v_and_b32 v56, v61, v16
    v_and_b32 v57, v61, v17
    v_and_b32 v58, v61, v18
    v_and_b32 v59, v61, v19
    s_nop 0
    s_waitcnt vmcnt(4)
    v_mfma_f32_16x16x32_bf16 v[32:35], v[56:59], v[96:99], v[32:35]
    buffer_load_dwordx4 v[96:99], v6, s[20:23], s47 offen offset:0 nt
    s_waitcnt vmcnt(4)
    v_mfma_f32_16x16x32_bf16 v[36:39], v[56:59], v[100:103], v[36:39]
    buffer_load_dwordx4 v[100:103], v6, s[20:23], s47 offen offset:128 nt
    s_waitcnt vmcnt(4)
    v_mfma_f32_16x16x32_bf16 v[40:43], v[56:59], v[104:107], v[40:43]
    buffer_load_dwordx4 v[104:107], v6, s[20:23], s47 offen offset:256 nt
    s_add_u32 s86, s86, 4
    s_cmp_ge_u32 s86, 63
    s_cselect_b32 s3, 63, 0
    s_cselect_b32 s4, 196608, 0
    s_sub_u32 s86, s86, s3
    s_add_u32 s87, s87, s4
    s_cmp_eq_u32 s87, s18
    s_cselect_b32 s87, 0, s87
    s_mul_i32 s3, s86, 49
    s_lshr_b32 s3, s3, 10
    s_mul_i32 s3, s3, 33408
    s_mul_i32 s47, s86, 1536
    s_add_u32 s3, s3, s87
    s_add_u32 s47, s47, s3
    v_and_b32 v52, v62, v16
    v_and_b32 v53, v62, v17
    v_and_b32 v54, v62, v18
    v_and_b32 v55, v62, v19
    s_nop 0
    s_waitcnt vmcnt(4)
    v_mfma_f32_16x16x32_bf16 v[32:35], v[52:55], v[108:111], v[32:35]
    buffer_load_dwordx4 v[108:111], v6, s[20:23], s47 offen offset:0 nt
    s_waitcnt vmcnt(4)
    v_mfma_f32_16x16x32_bf16 v[36:39], v[52:55], v[112:115], v[36:39]
    buffer_load_dwordx4 v[112:115], v6, s[20:23], s47 offen offset:128 nt
    s_waitcnt vmcnt(4)
    v_mfma_f32_16x16x32_bf16 v[40:43], v[52:55], v[116:119], v[40:43]
    buffer_load_dwordx4 v[116:119], v6, s[20:23], s47 offen offset:256 nt
    s_add_u32 s86, s86, 4
    s_cmp_ge_u32 s86, 63
    s_cselect_b32 s3, 63, 0
    s_cselect_b32 s4, 196608, 0
    s_sub_u32 s86, s86, s3
    s_add_u32 s87, s87, s4
    s_cmp_eq_u32 s87, s18
    s_cselect_b32 s87, 0, s87
    s_mul_i32 s3, s86, 49
    s_lshr_b32 s3, s3, 10
    s_mul_i32 s3, s3, 33408
    s_mul_i32 s47, s86, 1536
    s_add_u32 s3, s3, s87
    s_add_u32 s47, s47, s3
    v_and_b32 v56, v63, v16
    v_and_b32 v57, v63, v17
    v_and_b32 v58, v63, v18
    v_and_b32 v59, v63, v19
    s_nop 0
    s_waitcnt vmcnt(4)
    v_mfma_f32_16x16x32_bf16 v[32:35], v[56:59], v[120:123], v[32:35]
    buffer_load_dwordx4 v[120:123], v6, s[20:23], s47 offen offset:0 nt
    s_waitcnt vmcnt(4)
    v_mfma_f32_16x16x32_bf16 v[36:39], v[56:59], v[124:127], v[36:39]
    buffer_load_dwordx4 v[124:127], v6, s[20:23], s47 offen offset:128 nt
    s_waitcnt vmcnt(4)
    v_mfma_f32_16x16x32_bf16 v[40:43], v[56:59], v[128:131], v[40:43]
    buffer_load_dwordx4 v[128:131], v6, s[20:23], s47 offen offset:256 nt
    s_add_u32 s86, s86, 4
    s_cmp_ge_u32 s86, 63
    s_cselect_b32 s3, 63, 0
    s_cselect_b32 s4, 196608, 0
    s_sub_u32 s86, s86, s3
    s_add_u32 s87, s87, s4
    s_cmp_eq_u32 s87, s18
    s_cselect_b32 s87, 0, s87
    s_mul_i32 s3, s86, 49
    s_lshr_b32 s3, s3, 10
    s_mul_i32 s3, s3, 33408
    s_mul_i32 s47, s86, 1536
    s_add_u32 s3, s3, s87
    s_add_u32 s47, s47, s3
    s_waitcnt lgkmcnt(0)
    v_and_b32 v52, v64, v16
    v_and_b32 v53, v64, v17
    v_and_b32 v54, v64, v18
    v_and_b32 v55, v64, v19
    ds_read_b128 v[60:63], v81 offset:32
    s_waitcnt vmcnt(4)
    v_mfma_f32_16x16x32_bf16 v[32:35], v[52:55], v[84:87], v[32:35]
    buffer_load_dwordx4 v[84:87], v6, s[20:23], s47 offen offset:0 nt
    s_waitcnt vmcnt(4)
    v_mfma_f32_16x16x32_bf16 v[36:39], v[52:55], v[88:91], v[36:39]
    buffer_load_dwordx4 v[88:91], v6, s[20:23], s47 offen offset:128 nt
    s_waitcnt vmcnt(4)
    v_mfma_f32_16x16x32_bf16 v[40:43], v[52:55], v[92:95], v[40:43]
    buffer_load_dwordx4 v[92:95], v6, s[20:23], s47 offen offset:256 nt
    s_add_u32 s86, s86, 4
    s_cmp_ge_u32 s86, 63
    s_cselect_b32 s3, 63, 0
    s_cselect_b32 s4, 196608, 0
    s_sub_u32 s86, s86, s3
    s_add_u32 s87, s87, s4
    s_cmp_eq_u32 s87, s18
    s_cselect_b32 s87, 0, s87
    s_mul_i32 s3, s86, 49
    s_lshr_b32 s3, s3, 10
    s_mul_i32 s3, s3, 33408
    s_mul_i32 s47, s86, 1536
    s_add_u32 s3, s3, s87
    s_add_u32 s47, s47, s3
    v_and_b32 v56, v65, v16
    v_and_b32 v57, v65, v17
    v_and_b32 v58, v65, v18
    v_and_b32 v59, v65, v19
    s_nop 0
    s_waitcnt vmcnt(4)
    v_mfma_f32_16x16x32_bf16 v[32:35], v[56:59], v[96:99], v[32:35]
    buffer_load_dwordx4 v[96:99], v6, s[20:23], s47 offen offset:0 nt
    s_waitcnt vmcnt(4)
    v_mfma_f32_16x16x32_bf16 v[36:39], v[56:59], v[100:103], v[36:39]
    buffer_load_dwordx4 v[100:103], v6, s[20:23], s47 offen offset:128 nt
    s_waitcnt vmcnt(4)
    v_mfma_f32_16x16x32_bf16 v[40:43], v[56:59], v[104:107], v[40:43]
    buffer_load_dwordx4 v[104:107], v6, s[20:23], s47 offen offset:256 nt
    s_add_u32 s86, s86, 4
    s_cmp_ge_u32 s86, 63
    s_cselect_b32 s3, 63, 0
    s_cselect_b32 s4, 196608, 0
    s_sub_u32 s86, s86, s3
    s_add_u32 s87, s87, s4
    s_cmp_eq_u32 s87, s18
    s_cselect_b32 s87, 0, s87
    s_mul_i32 s3, s86, 49
    s_lshr_b32 s3, s3, 10
    s_mul_i32 s3, s3, 33408
    s_mul_i32 s47, s86, 1536
    s_add_u32 s3, s3, s87
    s_add_u32 s47, s47, s3
    v_and_b32 v52, v66, v16
    v_and_b32 v53, v66, v17
    v_and_b32 v54, v66, v18
    v_and_b32 v55, v66, v19
    s_nop 0
    s_waitcnt vmcnt(4)
    v_mfma_f32_16x16x32_bf16 v[32:35], v[52:55], v[108:111], v[32:35]
    buffer_load_dwordx4 v[108:111], v6, s[20:23], s47 offen offset:0 nt
    s_waitcnt vmcnt(4)
    v_mfma_f32_16x16x32_bf16 v[36:39], v[52:55], v[112:115], v[36:39]
    buffer_load_dwordx4 v[112:115], v6, s[20:23], s47 offen offset:128 nt
    s_waitcnt vmcnt(4)
    v_mfma_f32_16x16x32_bf16 v[40:43], v[52:55], v[116:119], v[40:43]
    buffer_load_dwordx4 v[116:119], v6, s[20:23], s47 offen offset:256 nt
    s_add_u32 s86, s86, 4
    s_cmp_ge_u32 s86, 63
    s_cselect_b32 s3, 63, 0
    s_cselect_b32 s4, 196608, 0
    s_sub_u32 s86, s86, s3
    s_add_u32 s87, s87, s4
    s_cmp_eq_u32 s87, s18
    s_cselect_b32 s87, 0, s87
    s_mul_i32 s3, s86, 49
    s_lshr_b32 s3, s3, 10
    s_mul_i32 s3, s3, 33408
    s_mul_i32 s47, s86, 1536
    s_add_u32 s3, s3, s87
    s_add_u32 s47, s47, s3
    v_and_b32 v56, v67, v16
    v_and_b32 v57, v67, v17
    v_and_b32 v58, v67, v18
    v_and_b32 v59, v67, v19
    s_nop 0
    s_waitcnt vmcnt(4)
    v_mfma_f32_16x16x32_bf16 v[32:35], v[56:59], v[120:123], v[32:35]
    buffer_load_dwordx4 v[120:123], v6, s[20:23], s47 offen offset:0 nt
    s_waitcnt vmcnt(4)
    v_mfma_f32_16x16x32_bf16 v[36:39], v[56:59], v[124:127], v[36:39]
    buffer_load_dwordx4 v[124:127], v6, s[20:23], s47 offen offset:128 nt
    s_waitcnt vmcnt(4)
    v_mfma_f32_16x16x32_bf16 v[40:43], v[56:59], v[128:131], v[40:43]
    buffer_load_dwordx4 v[128:131], v6, s[20:23], s47 offen offset:256 nt
    s_add_u32 s86, s86, 4
    s_cmp_ge_u32 s86, 63
    s_cselect_b32 s3, 63, 0
    s_cselect_b32 s4, 196608, 0
    s_sub_u32 s86, s86, s3
    s_add_u32 s87, s87, s4
    s_cmp_eq_u32 s87, s18
    s_cselect_b32 s87, 0, s87
    s_mul_i32 s3, s86, 49
    s_lshr_b32 s3, s3, 10
    s_mul_i32 s3, s3, 33408
    s_mul_i32 s47, s86, 1536
    s_add_u32 s3, s3, s87
    s_add_u32 s47, s47, s3
    s_waitcnt lgkmcnt(0)
    v_and_b32 v52, v60, v16
    v_and_b32 v53, v60, v17
    v_and_b32 v54, v60, v18
    v_and_b32 v55, v60, v19
    ds_read_b128 v[64:67], v81 offset:48
    v_add_u32 v81, 32, v81
    s_setpc_b64 s[58:59]
L_anchor:
    s_cmp_lt_i32 s77, 0
    s_cbranch_scc1 L_an1
    s_sub_u32 s5, s4, 4000
    v_subrev_u32 v72, s5, v72
    s_movk_i32 s3, 6000
    v_cmp_gt_u32 vcc, s3, v72
    s_cmp_eq_u64 vcc, -1
    s_cbranch_scc0 L_an0
    v_add_u32_dpp v72, v72, v72 quad_perm:[1,0,3,2] row_mask:0xf bank_mask:0xf
    s_nop 1
    v_add_u32_dpp v72, v72, v72 quad_perm:[2,3,0,1] row_mask:0xf bank_mask:0xf
    s_nop 1
    v_add_u32_dpp v72, v72, v72 row_ror:4 row_mask:0xf bank_mask:0xf
    s_nop 1
    v_add_u32_dpp v72, v72, v72 row_ror:8 row_mask:0xf bank_mask:0xf
    s_nop 1
    v_readlane_b32 s3, v72, 0
    v_readlane_b32 s6, v72, 16
    s_add_u32 s3, s3, s6
    s_lshr_b32 s3, s3, 5
    s_add_u32 s3, s3, s5
    s_sub_i32 s6, s77, s79
    s_bcnt1_i32_b32 s7, s6
    s_cmp_eq_u32 s7, 1
    s_cbranch_scc0 L_an2
    s_ff1_i32_b32 s7, s6
    s_sub_u32 s6, s3, s78
    s_lshr_b32 s82, s6, s7
L_an2:
    s_mov_b32 s78, s3
    s_mov_b32 s79, s77
    s_sub_u32 s6, s76, s77
    s_mul_i32 s6, s6, s82
    s_add_u32 s80, s3, s6
L_an0:
    s_mov_b32 s77, -1
L_an1:
    s_mov_b32 s6, 0x288822a
    s_bitcmp1_b32 s6, s76
    s_cbranch_scc0 L_an4
    s_cmp_ge_u32 s2, 32
    s_cbranch_scc1 L_an4
    s_cmp_lg_u32 s13, 0
    s_cbranch_scc1 L_an4
    s_lshl_b32 s3, s76, 8
    v_add_u32 v8, s3, v73
    v_mov_b32 v9, s4
    s_lshl_b64 exec, 1, s2
    global_store_dword v8, v9, s[92:93] sc1
    s_mov_b64 exec, -1
L_an4:
    s_mov_b32 s6, 0xa2208a8
    s_bitcmp1_b32 s6, s76
    s_cbranch_scc0 L_an3
    s_sub_u32 s77, s76, 2
    s_lshl_b32 s3, s77, 8
    v_add_u32 v8, s3, v73
    global_load_dword v72, v8, s[92:93]
L_an3:
    s_add_u32 s76, s76, 1
    s_setpc_b64 s[84:85]
.section .rodata,"a"
.p2align 6
.amdhsa_kernel concat_heads__gqa_block_cached__mha_block_cached__decode_kernel
  .amdhsa_next_free_vgpr 496
  .amdhsa_next_free_sgpr 100
  .amdhsa_accum_offset 256
  .amdhsa_group_segment_fixed_size 0
  .amdhsa_kernarg_size 104
  .amdhsa_user_sgpr_count 2
  .amdhsa_user_sgpr_kernarg_segment_ptr 1
  .amdhsa_system_sgpr_workgroup_id_x 1
  .amdhsa_float_denorm_mode_32 3
.end_amdhsa_kernel
```
